```python
import torch

def _softmax(x, axis=-1):
    return torch.softmax(x, dim=axis)
def _gelu(x):
    return torch.nn.functional.gelu(x, approximate="tanh")
def _silu(x):
    return torch.nn.functional.silu(x)
def _sigmoid(x):
    return torch.sigmoid(x)
def _layernorm(x, axis=-1, eps=1e-5):
    m = x.mean(dim=axis, keepdim=True)
    v = x.var(dim=axis, keepdim=True, unbiased=False)
    return (x - m) / torch.sqrt(v + eps)
def _scatter_add(tgt, idx, src, axis=0):
    return tgt.clone().index_add_(axis, idx, src)
def _segment_sum(src, seg, n):
    out = torch.zeros((n,) + src.shape[1:], dtype=src.dtype)
    return out.index_add_(0, seg, src)
def _pad(x, pw):
    flat = tuple(v for pair in reversed(pw) for v in pair)
    return torch.nn.functional.pad(x, flat)

kernel_name = 'recurrent_scan__gqa_block_cached__mixer_channel_mlp__decode'

def setup_inputs():

    _w = (lambda a: (lambda t: t.to(torch.bfloat16) if t.is_floating_point() else t)(torch.as_tensor(a)))
    def _A_setup():
        B, Sq, D = 4, 1, 512
        Hq, Hkv, Sk, Dh = 32, 8, 8192, 128
        assert Hq % Hkv == 0, (Hq, Hkv)
        return {
            "x": _w((lambda *s: torch.randn(*s, dtype=torch.bfloat16) * 0.1)(B, Sq, D)),
            "k_cache": _w((lambda *s: torch.randn(*s, dtype=torch.bfloat16) * 0.8)(B, Hkv, Sk, Dh)),
            "v_cache": _w((lambda *s: torch.randn(*s, dtype=torch.bfloat16) * 3.2)(B, Hkv, Sk, Dh)),
            "wq": _w((lambda *s: torch.randn(*s, dtype=torch.bfloat16) * 0.8)(D, Hq * Dh) * (D ** -0.5)),
            "wo": _w((lambda *s: torch.randn(*s, dtype=torch.bfloat16) * 3.2)(Hq * Dh, D) * ((Hq * Dh) ** -0.5)),
        }
    _A_in = _A_setup()

    def _B_setup():
        B, S, D, F = 4, 1, 512, 1792
        return {
            "x": _w((lambda *s: torch.randn(*s, dtype=torch.bfloat16) * 0.1)(B, S, D)),
            "w1": _w((lambda *s: torch.randn(*s, dtype=torch.bfloat16) * 3.2)(D, F) * (D ** -0.5)),
            "b1": _w((lambda *s: torch.randn(*s, dtype=torch.bfloat16) * 3.2)(F)),
            "w2": _w((lambda *s: torch.randn(*s, dtype=torch.bfloat16) * 3.2)(F, D) * (F ** -0.5)),
            "b2": _w((lambda *s: torch.randn(*s, dtype=torch.bfloat16) * 3.2)(D)),
        }
    _B_in = _B_setup()

    return {
        "A_x": _A_in["x"],
        "A_k_cache": _A_in["k_cache"],
        "A_v_cache": _A_in["v_cache"],
        "A_wq": _A_in["wq"],
        "A_wo": _A_in["wo"],
        "B_x": _B_in["x"],
        "B_w1": _B_in["w1"],
        "B_b1": _B_in["b1"],
        "B_w2": _B_in["w2"],
        "B_b2": _B_in["b2"],
    }

def reference(A_x, A_k_cache, A_v_cache, A_wq, A_wo, B_x, B_w1, B_b1, B_w2, B_b2):
    def _A_ref(x, k_cache, v_cache, wq, wo):
        B, Sq, D = x.shape
        Hq, Dh = 32, 128
        Hkv = k_cache.shape[1]
        rep = Hq // Hkv
        q = (lambda x, *d: x.permute(*d))((x @ wq).reshape(B, Sq, Hq, Dh), 0, 2, 1, 3)
        k = (lambda x, n, axis: torch.repeat_interleave(x, n, dim=axis))(k_cache, rep, axis=1)
        v = (lambda x, n, axis: torch.repeat_interleave(x, n, dim=axis))(v_cache, rep, axis=1)
        scores = torch.einsum("bhqd,bhkd->bhqk", q, k) * (Dh ** -0.5)
        p = _softmax(scores, axis=-1)
        o = torch.einsum("bhqk,bhkd->bhqd", p, v)
        return (lambda x, *d: x.permute(*d))(o, 0, 2, 1, 3).reshape(B, Sq, Hq * Dh) @ wo

    def _B_ref(x, w1, b1, w2, b2):
        y = _layernorm(x, axis=-1)
        h = _gelu(torch.einsum("bsd,df->bsf", y, w1) + b1)
        return torch.einsum("bsf,fd->bsd", h, w2) + b2

    x = A_x
    xn = _layernorm(x, axis=-1)
    s = _A_ref(xn, A_k_cache, A_v_cache, A_wq, A_wo)
    g = _silu(_B_ref(xn, B_w1, B_b1, B_w2, B_b2))
    return x + s * g
```

```asm
; @launch grid=(256,1,1) block=(512,1,1) lds=163840
.amdgcn_target "amdgcn-amd-amdhsa--gfx950"
.text
.globl recurrent_scan__gqa_block_cached__mixer_channel_mlp__decode_kernel
.p2align 8
.type recurrent_scan__gqa_block_cached__mixer_channel_mlp__decode_kernel,@function
recurrent_scan__gqa_block_cached__mixer_channel_mlp__decode_kernel:
    s_load_dwordx16 s[4:19], s[0:1], 0
    s_load_dwordx8 s[20:27], s[0:1], 64
    s_load_dwordx2 s[28:29], s[0:1], 96
    s_memrealtime s[76:77]
    s_cmp_ge_u32 s2, 256
    s_cbranch_scc1 L_end
    v_lshrrev_b32 v1, 6, v0
    v_and_b32 v0, 63, v0
    v_readfirstlane_b32 s3, v1
    v_lshrrev_b32 v2, 4, v0
    v_and_b32 v3, 15, v0
    v_mov_b32 v21, 147456
    s_mov_b32 s71, 0x200000
    s_lshr_b32 s52, s2, 5
    s_and_b32 s53, s2, 31
    s_and_b32 s54, s53, 7
    s_lshr_b32 s55, s53, 3
    s_cmp_eq_u32 s3, 0
    s_cbranch_scc1 L_isL
    s_cmp_eq_u32 s3, 3
    s_cbranch_scc0 L_notL
    s_mov_b64 exec, 0
    s_branch Lpad_L_0
Lret_L:
    s_mov_b64 exec, -1
    s_branch L_notL
L_isL:
    s_setprio 3
    v_mov_b64 v[24:25], 0
    v_mov_b64 v[26:27], 0
    ds_write_b128 v21, v[24:27]
    ds_write_b128 v21, v[24:27] offset:32
    v_mov_b32 v28, 0
    v_mov_b32 v25, 1
    v_mov_b32 v26, 2
    v_mov_b32 v27, 3
    ds_write_b128 v21, v[24:27] offset:16
    v_lshrrev_b32 v5, 3, v0
    v_and_b32 v6, 7, v0
    v_and_b32 v10, 1, v2
    v_lshlrev_b32 v10, 1, v10
    v_xor_b32 v6, v6, v10
    v_lshlrev_b32 v6, 4, v6
    v_lshl_add_u32 v8, v5, 13, v6
    v_xor_b32 v9, 64, v8
    v_lshlrev_b32 v4, 4, v0
    v_lshlrev_b32 v16, 1, v2
    v_xor_b32 v16, v16, v3
    v_lshlrev_b32 v16, 4, v16
    v_lshl_add_u32 v16, v2, 8, v16
    v_xor_b32 v17, 0x80, v16
    v_xor_b32 v18, 16, v16
    v_xor_b32 v19, 0x90, v16
    s_lshl_b32 s58, s55, 13
    s_add_u32 s58, s58, s52
    s_lshl_b32 s57, s54, 3
    s_add_u32 s58, s58, s57
    s_lshl_b32 s58, s58, 7
    s_lshl_b32 s67, s53, 21
    s_lshl_b32 s57, s52, 18
    s_add_u32 s67, s67, s57
    s_mov_b32 s62, 0
    s_mov_b32 m0, 131072
    s_waitcnt lgkmcnt(0)
    s_add_u32 s40, s10, s58
    s_addc_u32 s41, s11, 0
    s_mov_b32 s42, 1040512
    s_mov_b32 s43, 0x20000
L_wq:
    buffer_load_dwordx4 v8, s[40:43], s62 offen nt lds
    s_add_u32 m0, m0, 1024
    s_add_u32 s62, s62, 0x10000
    buffer_load_dwordx4 v9, s[40:43], s62 offen nt lds
    s_add_u32 m0, m0, 1024
    s_add_u32 s62, s62, 0x10000
    s_cmp_lt_u32 s62, 0x100000
    s_cbranch_scc1 L_wq
    s_mov_b32 m0, 151552
    s_mov_b32 s44, s4
    s_mov_b32 s45, s5
    s_mov_b32 s46, 4096
    s_mov_b32 s47, 0x20000
    buffer_load_dwordx4 v4, s[44:47], 0 offen offset:0 lds
    buffer_load_dwordx4 v4, s[44:47], 0 offen offset:1024 lds
    buffer_load_dwordx4 v4, s[44:47], 0 offen offset:2048 lds
    buffer_load_dwordx4 v4, s[44:47], 0 offen offset:3072 lds
    s_add_u32 s32, s6, s67
    s_addc_u32 s33, s7, 0
    s_add_u32 s34, s8, s67
    s_addc_u32 s35, s9, 0
    s_mov_b32 s46, 0x40000
    s_mov_b64 s[44:45], s[32:33]
    s_lshr_b32 s65, s2, 3
    s_and_b32 s65, s65, 7
    s_lshl_b32 s57, s52, 3
    s_or_b32 s65, s65, s57
    s_lshl_b32 s65, s65, 12
    s_mov_b32 s68, 0
L_burst:
    s_xor_b32 s63, s65, s68
    s_xor_b32 s64, s63, 4096
    s_mov_b32 m0, s68
    s_nop 0
    buffer_load_dwordx4 v16, s[44:47], s63 offen offset:0 nt lds
    buffer_load_dwordx4 v17, s[44:47], s63 offen offset:1024 nt lds
    buffer_load_dwordx4 v18, s[44:47], s63 offen offset:2048 nt lds
    buffer_load_dwordx4 v19, s[44:47], s63 offen offset:3072 nt lds
    s_add_u32 m0, s68, 4096
    s_nop 0
    buffer_load_dwordx4 v16, s[44:47], s64 offen offset:0 nt lds
    buffer_load_dwordx4 v17, s[44:47], s64 offen offset:1024 nt lds
    buffer_load_dwordx4 v18, s[44:47], s64 offen offset:2048 nt lds
    buffer_load_dwordx4 v19, s[44:47], s64 offen offset:3072 nt lds
    s_add_u32 s68, s68, 8192
    s_cmp_lt_u32 s68, 32768
    s_cbranch_scc1 L_burst
    s_mov_b32 s59, 4
    s_mov_b32 s60, 1
    s_mov_b32 s61, 15
    s_mov_b32 s78, s76
    s_mov_b32 s79, 2284
    v_mov_b32 v20, 1
    s_barrier
    s_waitcnt vmcnt(32)
    ds_write_b32 v21, v20
L_step:
Lpad_L_0:
    s_cbranch_execz Lpad_L_1
    s_sub_u32 s67, s59, 15
    s_waitcnt lgkmcnt(0)
    s_cmp_gt_i32 s67, 0
    s_cbranch_scc0 L_free
    v_min3_i32 v23, v24, v25, v26
    v_min_i32 v23, v23, v27
    s_nop 0
    v_readfirstlane_b32 s66, v23
    s_nop 0
    s_cmp_ge_i32 s66, s67
    s_cbranch_scc0 L_stall
L_free:
    s_and_b32 s63, s59, 31
    s_lshl_b32 s63, s63, 13
    s_xor_b32 s63, s63, s65
    s_and_b32 s68, s59, 15
    s_lshl_b32 s68, s68, 13
    s_bitcmp1_b32 s59, 5
    s_cselect_b64 s[44:45], s[34:35], s[32:33]
    s_add_u32 s59, s59, 1
    s_mov_b32 m0, s68
    s_xor_b32 s64, s63, 4096
    s_sub_u32 s57, s76, s78
    s_mul_i32 s57, s57, 10
    s_sub_u32 s57, s57, s79
    s_memrealtime s[76:77]
    s_cmp_ge_i32 s57, 0
    s_cbranch_scc1 L_kvhi1
    s_waitcnt vmcnt(20)
    buffer_load_dwordx4 v16, s[44:47], s63 offen offset:0 nt lds
    s_waitcnt vmcnt(20)
    buffer_load_dwordx4 v17, s[44:47], s63 offen offset:1024 nt lds
    s_waitcnt vmcnt(20)
    buffer_load_dwordx4 v18, s[44:47], s63 offen offset:2048 nt lds
    s_waitcnt vmcnt(20)
    buffer_load_dwordx4 v19, s[44:47], s63 offen offset:3072 nt lds
    s_add_u32 m0, s68, 4096
    s_waitcnt vmcnt(20)
    s_lshr_b32 s58, s61, 2
    s_bcnt1_i32_b32 s58, s58
    s_add_u32 s60, s60, s58
    s_and_b32 s61, s61, 3
    v_mov_b32 v20, s60
    ds_write_b32 v21, v20
    buffer_load_dwordx4 v16, s[44:47], s64 offen offset:0 nt lds
    s_waitcnt vmcnt(20)
    buffer_load_dwordx4 v17, s[44:47], s64 offen offset:1024 nt lds
    s_waitcnt vmcnt(20)
    buffer_load_dwordx4 v18, s[44:47], s64 offen offset:2048 nt lds
    ds_read_b128 v[24:27], v21 offset:16
    s_waitcnt vmcnt(20)
    buffer_load_dwordx4 v19, s[44:47], s64 offen offset:3072 nt lds
L_kvj:
Lpad_L_1:
    s_cbranch_execz Lpad_L_2
    s_lshl_b32 s61, s61, 1
    s_or_b32 s61, s61, 1
    s_add_u32 s79, s79, 271
    s_cmp_eq_u32 s59, 8
    s_cbranch_scc1 L_w1
    s_cmp_eq_u32 s59, 64
    s_cbranch_scc1 L_wo
    s_cmp_lt_u32 s59, 64
    s_cbranch_scc1 L_step
L_drain:
    s_waitcnt vmcnt(32)
    s_lshr_b32 s58, s61, 4
    s_bcnt1_i32_b32 s58, s58
    s_add_u32 s60, s60, s58
    s_and_b32 s61, s61, 15
    v_mov_b32 v20, s60
    ds_write_b32 v21, v20
    s_waitcnt vmcnt(24)
    s_lshr_b32 s58, s61, 3
    s_bcnt1_i32_b32 s58, s58
    s_add_u32 s60, s60, s58
    s_and_b32 s61, s61, 7
    v_mov_b32 v20, s60
    ds_write_b32 v21, v20
    s_waitcnt vmcnt(16)
    s_barrier
    s_waitcnt vmcnt(0)
    s_barrier
    s_waitcnt lgkmcnt(0)
    s_endpgm
L_kvhi1:
Lpad_L_2:
    s_cbranch_execz Lpad_L_3
    s_waitcnt vmcnt(35)
    buffer_load_dwordx4 v16, s[44:47], s63 offen offset:0 nt lds
    s_waitcnt vmcnt(35)
    buffer_load_dwordx4 v17, s[44:47], s63 offen offset:1024 nt lds
    s_waitcnt vmcnt(35)
    buffer_load_dwordx4 v18, s[44:47], s63 offen offset:2048 nt lds
    s_waitcnt vmcnt(35)
    s_lshr_b32 s58, s61, 4
    s_bcnt1_i32_b32 s58, s58
    s_add_u32 s60, s60, s58
    s_and_b32 s61, s61, 15
    v_mov_b32 v20, s60
    ds_write_b32 v21, v20
    buffer_load_dwordx4 v19, s[44:47], s63 offen offset:3072 nt lds
    s_add_u32 m0, s68, 4096
    s_waitcnt vmcnt(35)
    buffer_load_dwordx4 v16, s[44:47], s64 offen offset:0 nt lds
    s_waitcnt vmcnt(35)
    buffer_load_dwordx4 v17, s[44:47], s64 offen offset:1024 nt lds
    s_waitcnt vmcnt(35)
    buffer_load_dwordx4 v18, s[44:47], s64 offen offset:2048 nt lds
    ds_read_b128 v[24:27], v21 offset:16
    s_waitcnt vmcnt(35)
    buffer_load_dwordx4 v19, s[44:47], s64 offen offset:3072 nt lds
    s_branch L_kvj
L_stall:
    s_waitcnt vmcnt(32)
    s_lshr_b32 s58, s61, 4
    s_bcnt1_i32_b32 s58, s58
    s_add_u32 s60, s60, s58
    s_and_b32 s61, s61, 15
    v_mov_b32 v20, s60
    ds_write_b32 v21, v20
    ds_read_b128 v[24:27], v21 offset:16
    s_waitcnt lgkmcnt(0)
    v_min3_i32 v23, v24, v25, v26
    v_min_i32 v23, v23, v27
    s_nop 0
    v_readfirstlane_b32 s66, v23
    s_nop 0
    s_cmp_ge_i32 s66, s67
    s_cbranch_scc1 L_free
Lpad_L_3:
    s_cbranch_execz Lpad_L_4
    s_waitcnt vmcnt(24)
    s_lshr_b32 s58, s61, 3
    s_bcnt1_i32_b32 s58, s58
    s_add_u32 s60, s60, s58
    s_and_b32 s61, s61, 7
    v_mov_b32 v20, s60
    ds_write_b32 v21, v20
    ds_read_b128 v[24:27], v21 offset:16
    s_waitcnt lgkmcnt(0)
    v_min3_i32 v23, v24, v25, v26
    v_min_i32 v23, v23, v27
    s_nop 0
    v_readfirstlane_b32 s66, v23
    s_nop 0
    s_cmp_ge_i32 s66, s67
    s_cbranch_scc1 L_free
    s_waitcnt vmcnt(16)
    s_lshr_b32 s58, s61, 2
    s_bcnt1_i32_b32 s58, s58
    s_add_u32 s60, s60, s58
    s_and_b32 s61, s61, 3
    v_mov_b32 v20, s60
    ds_write_b32 v21, v20
    ds_read_b128 v[24:27], v21 offset:16
    s_waitcnt lgkmcnt(0)
    v_min3_i32 v23, v24, v25, v26
    v_min_i32 v23, v23, v27
    s_nop 0
    v_readfirstlane_b32 s66, v23
    s_nop 0
    s_cmp_ge_i32 s66, s67
    s_cbranch_scc1 L_free
    s_waitcnt vmcnt(8)
    s_lshr_b32 s58, s61, 1
    s_bcnt1_i32_b32 s58, s58
    s_add_u32 s60, s60, s58
    s_and_b32 s61, s61, 1
    v_mov_b32 v20, s60
    ds_write_b32 v21, v20
    ds_read_b128 v[24:27], v21 offset:16
    s_waitcnt lgkmcnt(0)
    v_min3_i32 v23, v24, v25, v26
    v_min_i32 v23, v23, v27
    s_nop 0
    v_readfirstlane_b32 s66, v23
    s_nop 0
    s_cmp_ge_i32 s66, s67
    s_cbranch_scc1 L_free
Lpad_L_4:
    s_cbranch_execz Lpad_L_5
    s_waitcnt vmcnt(0)
    s_lshr_b32 s58, s61, 0
    s_bcnt1_i32_b32 s58, s58
    s_add_u32 s60, s60, s58
    s_and_b32 s61, s61, 0
    v_mov_b32 v20, s60
    ds_write_b32 v21, v20
    ds_read_b128 v[24:27], v21 offset:16
    s_waitcnt lgkmcnt(0)
    v_min3_i32 v23, v24, v25, v26
    v_min_i32 v23, v23, v27
    s_nop 0
    v_readfirstlane_b32 s66, v23
    s_nop 0
    s_cmp_ge_i32 s66, s67
    s_cbranch_scc1 L_free
    s_sleep 1
    s_sub_u32 s71, s71, 1
    s_cbranch_scc0 L_stall
    s_endpgm
L_wtile:
    s_waitcnt lgkmcnt(0)
    s_sub_u32 s57, s76, s78
    s_mul_i32 s57, s57, 10
    s_sub_u32 s57, s57, s79
    s_memrealtime s[76:77]
    s_cmp_ge_i32 s57, 0
    s_cbranch_scc1 L_whi1
    s_waitcnt vmcnt(20)
    buffer_load_dwordx4 v8, s[40:43], s62 offen nt lds
    s_add_u32 m0, m0, 1024
    s_add_u32 s62, s62, s70
    s_waitcnt vmcnt(20)
    buffer_load_dwordx4 v9, s[40:43], s62 offen nt lds
    s_add_u32 m0, m0, 1024
    s_add_u32 s62, s62, s70
    s_waitcnt vmcnt(20)
    buffer_load_dwordx4 v8, s[40:43], s62 offen nt lds
    s_add_u32 m0, m0, 1024
    s_add_u32 s62, s62, s70
Lpad_L_5:
    s_cbranch_execz Lpad_L_6
    s_waitcnt vmcnt(20)
    buffer_load_dwordx4 v9, s[40:43], s62 offen nt lds
    s_add_u32 m0, m0, 1024
    s_add_u32 s62, s62, s70
    s_waitcnt vmcnt(20)
    s_lshr_b32 s58, s61, 2
    s_bcnt1_i32_b32 s58, s58
    s_add_u32 s60, s60, s58
    s_and_b32 s61, s61, 3
    v_mov_b32 v20, s60
    ds_write_b32 v21, v20
    buffer_load_dwordx4 v8, s[40:43], s62 offen nt lds
    s_add_u32 m0, m0, 1024
    s_add_u32 s62, s62, s70
    s_waitcnt vmcnt(20)
    buffer_load_dwordx4 v9, s[40:43], s62 offen nt lds
    s_add_u32 m0, m0, 1024
    s_add_u32 s62, s62, s70
    s_waitcnt vmcnt(20)
    buffer_load_dwordx4 v8, s[40:43], s62 offen nt lds
    s_add_u32 m0, m0, 1024
    s_add_u32 s62, s62, s70
    s_waitcnt vmcnt(20)
    buffer_load_dwordx4 v9, s[40:43], s62 offen nt lds
    s_add_u32 m0, m0, 1024
    s_add_u32 s62, s62, s70
L_wj:
    s_lshl_b32 s61, s61, 1
    s_add_u32 s79, s79, 271
    s_sub_u32 s69, s69, 1
    s_cbranch_scc0 L_wtile
    s_cmp_lt_u32 s59, 64
    s_cbranch_scc1 L_step
    s_branch L_drain
L_whi1:
    s_waitcnt vmcnt(35)
    buffer_load_dwordx4 v8, s[40:43], s62 offen nt lds
    s_add_u32 m0, m0, 1024
    s_add_u32 s62, s62, s70
Lpad_L_6:
    s_cbranch_execz Lpad_L_7
    s_waitcnt vmcnt(35)
    buffer_load_dwordx4 v9, s[40:43], s62 offen nt lds
    s_add_u32 m0, m0, 1024
    s_add_u32 s62, s62, s70
    s_waitcnt vmcnt(35)
    buffer_load_dwordx4 v8, s[40:43], s62 offen nt lds
    s_add_u32 m0, m0, 1024
    s_add_u32 s62, s62, s70
    s_waitcnt vmcnt(35)
    s_lshr_b32 s58, s61, 4
    s_bcnt1_i32_b32 s58, s58
    s_add_u32 s60, s60, s58
    s_and_b32 s61, s61, 15
    v_mov_b32 v20, s60
    ds_write_b32 v21, v20
    buffer_load_dwordx4 v9, s[40:43], s62 offen nt lds
    s_add_u32 m0, m0, 1024
    s_add_u32 s62, s62, s70
    s_waitcnt vmcnt(35)
    buffer_load_dwordx4 v8, s[40:43], s62 offen nt lds
    s_add_u32 m0, m0, 1024
    s_add_u32 s62, s62, s70
    s_waitcnt vmcnt(35)
    buffer_load_dwordx4 v9, s[40:43], s62 offen nt lds
    s_add_u32 m0, m0, 1024
    s_add_u32 s62, s62, s70
    s_waitcnt vmcnt(35)
    buffer_load_dwordx4 v8, s[40:43], s62 offen nt lds
    s_add_u32 m0, m0, 1024
    s_add_u32 s62, s62, s70
    s_waitcnt vmcnt(35)
    buffer_load_dwordx4 v9, s[40:43], s62 offen nt lds
    s_add_u32 m0, m0, 1024
    s_add_u32 s62, s62, s70
    s_branch L_wj
L_w1:
    s_cmp_lt_u32 s52, 4
    s_cbranch_scc1 L_w2
    s_sub_u32 s58, s52, 4
    s_lshl_b32 s58, s58, 5
    s_add_u32 s58, s58, s53
    s_cmp_ge_u32 s58, 112
    s_cbranch_scc1 L_step
    s_and_b32 s57, s58, 3
    s_lshr_b32 s58, s58, 2
    s_mul_i32 s57, s57, 3584
    s_add_u32 s58, s58, s57
    s_lshl_b32 s58, s58, 7
    v_mul_u32_u24 v8, 3584, v5
    v_add_u32 v8, v8, v6
    s_mov_b32 s70, 28672
    s_add_u32 s40, s16, s58
    s_addc_u32 s41, s17, 0
    s_mov_b32 s42, 455296
    s_mov_b32 s43, 0x20000
    s_branch L_wmid
L_w2:
    s_lshl_b32 s57, s55, 2
    s_add_u32 s57, s57, s52
    s_mul_i32 s57, s57, 114688
    s_lshl_b32 s58, s54, 7
    s_add_u32 s57, s57, s58
    v_lshl_add_u32 v8, v5, 10, v6
    s_mov_b32 s70, 8192
    s_add_u32 s40, s20, s57
    s_addc_u32 s41, s21, 0
    s_mov_b32 s42, 113792
    s_mov_b32 s43, 0x20000
L_wmid:
Lpad_L_7:
    s_cbranch_execz Lpad_L_8
L_lw1:
    ds_read_b32 v20, v21 offset:8
    s_waitcnt lgkmcnt(0)
    v_readfirstlane_b32 s69, v20
    s_nop 0
    s_cmp_ge_i32 s69, 1
    s_cbranch_scc1 L_lw1_ok
    s_sleep 1
    s_sub_u32 s71, s71, 1
    s_cbranch_scc0 L_lw1
    s_endpgm
L_lw1_ok:
    v_xor_b32 v9, 64, v8
    s_mov_b32 s62, 0
    s_mov_b32 s69, 1
    s_mov_b32 m0, 131072
    s_branch L_wtile
L_wo:
L_lw2:
    ds_read_b32 v20, v21 offset:12
    s_waitcnt lgkmcnt(0)
    v_readfirstlane_b32 s70, v20
    s_nop 0
    s_cmp_ge_i32 s70, 1
    s_cbranch_scc1 L_lw2_ok
    s_sleep 1
    s_sub_u32 s71, s71, 1
    s_cbranch_scc0 L_lw2
    s_endpgm
L_lw2_ok:
    s_lshl_b32 s57, s54, 2
    s_add_u32 s57, s57, s55
    s_lshl_b32 s57, s57, 17
    s_lshl_b32 s58, s52, 7
    s_add_u32 s57, s57, s58
    v_lshl_add_u32 v8, v5, 10, v6
    v_xor_b32 v9, 64, v8
    s_mov_b32 s62, 0
    s_mov_b32 s69, 1
    s_mov_b32 s70, 8192
    s_mov_b32 m0, 131072
Lpad_L_8:
    s_cbranch_execz Lret_L
    s_add_u32 s40, s12, s57
    s_addc_u32 s41, s13, 0
    s_mov_b32 s42, 130176
    s_mov_b32 s43, 0x20000
    s_branch L_wtile
L_notL:
    s_cmp_ge_u32 s3, 4
    s_cbranch_scc1 L_C
    s_cmp_eq_u32 s3, 1
    s_cbranch_scc1 L_nb0
    s_barrier
L_nb0:
    s_setprio 2
    v_and_b32 v10, 1, v2
    v_bfe_u32 v7, v0, 3, 1
    v_lshl_add_u32 v7, v10, 1, v7
    v_lshlrev_b32 v7, 5, v7
    v_and_b32 v10, 3, v0
    v_lshl_add_u32 v7, v10, 3, v7
    v_bfe_u32 v10, v0, 2, 2
    v_lshl_add_u32 v7, v10, 7, v7
    v_lshl_add_u32 v7, v2, 10, v7
    v_and_b32 v1, 7, v0
    v_lshlrev_b32 v1, 3, v1
    v_lshl_add_u32 v1, v2, 1, v1
    v_lshlrev_b32 v30, 3, v3
    v_lshlrev_b32 v29, 4, v0
    s_waitcnt lgkmcnt(0)
    s_mov_b32 s40, s28
    s_mov_b32 s41, s29
    s_mov_b32 s42, 4194304
    s_mov_b32 s43, 0x20000
    s_cmp_eq_u32 s3, 3
    s_cbranch_scc1 L_A2
    s_mov_b32 s57, s55
    s_mov_b32 s59, 1
    s_cmp_eq_u32 s3, 1
    s_cbranch_scc0 L_A1
    s_load_dword s30, s[28:29], 0
L_qh:
    s_mov_b32 s60, 0x3f803f80
    s_mov_b32 s61, 0x3f803f80
    v_mov_b64 v[32:33], s[60:61]
    v_mov_b64 v[34:35], s[60:61]
    v_mov_b64 v[36:37], s[60:61]
    v_mov_b64 v[38:39], s[60:61]
    v_mov_b64 v[40:41], s[60:61]
    v_mov_b64 v[42:43], s[60:61]
    v_mov_b64 v[44:45], s[60:61]
    v_mov_b64 v[46:47], s[60:61]
    v_mov_b64 v[48:49], s[60:61]
    v_mov_b64 v[50:51], s[60:61]
    v_mov_b64 v[52:53], s[60:61]
    v_mov_b64 v[54:55], s[60:61]
    v_mov_b64 v[56:57], s[60:61]
    v_mov_b64 v[58:59], s[60:61]
    v_mov_b64 v[60:61], s[60:61]
    v_mov_b64 v[62:63], s[60:61]
    v_mov_b64 v[64:65], s[60:61]
    v_mov_b64 v[66:67], s[60:61]
    v_mov_b64 v[68:69], s[60:61]
    v_mov_b64 v[70:71], s[60:61]
    v_mov_b64 v[72:73], s[60:61]
    v_mov_b64 v[74:75], s[60:61]
    v_mov_b64 v[76:77], s[60:61]
    v_mov_b64 v[78:79], s[60:61]
    v_mov_b64 v[80:81], s[60:61]
    v_mov_b64 v[82:83], s[60:61]
    v_mov_b64 v[84:85], s[60:61]
    v_mov_b64 v[86:87], s[60:61]
    v_mov_b64 v[88:89], s[60:61]
    v_mov_b64 v[90:91], s[60:61]
    v_mov_b64 v[92:93], s[60:61]
    v_mov_b64 v[94:95], s[60:61]
    v_add_u32 v12, 131072, v7
    v_xor_b32 v13, 32, v12
    v_xor_b32 v14, 64, v12
    v_xor_b32 v15, 0x60, v12
    v_lshlrev_b32 v4, 10, v3
    v_lshl_add_u32 v4, v2, 4, v4
    v_add_u32 v4, 151552, v4
    s_lshl_b32 s62, s57, 8
    v_add_u32 v24, s62, v4
    s_add_u32 s62, s62, 256
    s_and_b32 s62, s62, 0x3ff
    v_add_u32 v25, s62, v4
    s_add_u32 s62, s62, 256
    s_and_b32 s62, s62, 0x3ff
    v_add_u32 v26, s62, v4
    s_add_u32 s62, s62, 256
    s_and_b32 s62, s62, 0x3ff
    v_add_u32 v27, s62, v4
    v_and_b32 v10, 3, v3
    v_lshlrev_b32 v17, 2, v10
    v_add_u32 v17, 64, v17
    v_lshlrev_b32 v11, 16, v10
    s_lshl_b32 s62, s57, 11
    s_lshl_b32 s60, s54, 13
    s_add_u32 s62, s62, s60
    s_add_u32 s62, s62, 65536
    s_mov_b32 s60, s52
    s_cmp_eq_u32 s3, 1
    s_cbranch_scc1 L_q1
    v_mul_u32_u24 v11, 7168, v10
    s_mul_i32 s62, s57, 28672
    s_add_u32 s62, s62, 327680
    s_mov_b32 s60, s58
L_q1:
    v_lshrrev_b32 v10, 2, v3
    v_lshl_add_u32 v11, v10, 6, v11
    v_lshl_add_u32 v16, v2, 4, v11
    s_lshl_b32 s60, s60, 8
    s_add_u32 s73, s62, s60
    s_getreg_b32 s63, hwreg(HW_REG_XCC_ID, 0, 4)
    s_cmp_eq_u32 s3, 1
    s_cbranch_scc0 L_nb1
    s_barrier
L_nb1:
L_lw3:
    ds_read_b32 v20, v21 offset:0
    s_waitcnt lgkmcnt(0)
    v_readfirstlane_b32 s56, v20
    s_nop 0
    s_cmp_ge_i32 s56, s59
    s_cbranch_scc1 L_lw3_ok
    s_sub_u32 s71, s71, 1
    s_cbranch_scc0 L_lw3
    s_endpgm
L_lw3_ok:
    s_mov_b32 exec_lo, 0x000f000f
    s_mov_b32 exec_hi, 0x000f000f
    ds_read_b128 v[32:35], v24 offset:0
    ds_read_b128 v[36:39], v24 offset:64
    ds_read_b128 v[40:43], v24 offset:128
    ds_read_b128 v[44:47], v24 offset:192
    s_mov_b64 exec, -1
    ds_read_b64_tr_b16 v[96:97], v12 offset:0
    ds_read_b64_tr_b16 v[98:99], v12 offset:512
    ds_read_b64_tr_b16 v[100:101], v13 offset:0
    ds_read_b64_tr_b16 v[102:103], v13 offset:512
    ds_read_b64_tr_b16 v[104:105], v14 offset:0
    ds_read_b64_tr_b16 v[106:107], v14 offset:512
    ds_read_b64_tr_b16 v[108:109], v15 offset:0
    ds_read_b64_tr_b16 v[110:111], v15 offset:512
    s_waitcnt lgkmcnt(0)
    s_mov_b32 exec_lo, 0x000f000f
    s_mov_b32 exec_hi, 0x000f000f
    ds_read_b128 v[48:51], v25 offset:0
    ds_read_b128 v[52:55], v25 offset:64
    ds_read_b128 v[56:59], v25 offset:128
    ds_read_b128 v[60:63], v25 offset:192
    s_mov_b64 exec, -1
    ds_read_b64_tr_b16 v[112:113], v12 offset:4096
    ds_read_b64_tr_b16 v[114:115], v12 offset:4608
    ds_read_b64_tr_b16 v[116:117], v13 offset:4096
    ds_read_b64_tr_b16 v[118:119], v13 offset:4608
    ds_read_b64_tr_b16 v[120:121], v14 offset:4096
    ds_read_b64_tr_b16 v[122:123], v14 offset:4608
    ds_read_b64_tr_b16 v[124:125], v15 offset:4096
    ds_read_b64_tr_b16 v[126:127], v15 offset:4608
    v_mfma_f32_16x16x32_bf16 v[160:163], v[32:35], v[32:35], 0
    v_mfma_f32_16x16x32_bf16 v[160:163], v[36:39], v[36:39], v[160:163]
    v_mfma_f32_16x16x32_bf16 v[160:163], v[40:43], v[40:43], v[160:163]
    v_mfma_f32_16x16x32_bf16 v[160:163], v[44:47], v[44:47], v[160:163]
    v_mfma_f32_16x16x32_bf16 v[164:167], v[96:99], v[32:35], 0
    v_mfma_f32_16x16x32_bf16 v[168:171], v[100:103], v[32:35], 0
    v_mfma_f32_16x16x32_bf16 v[172:175], v[104:107], v[32:35], 0
    v_mfma_f32_16x16x32_bf16 v[176:179], v[108:111], v[32:35], 0
    s_waitcnt lgkmcnt(0)
    s_mov_b32 exec_lo, 0x000f000f
    s_mov_b32 exec_hi, 0x000f000f
    ds_read_b128 v[64:67], v26 offset:0
    ds_read_b128 v[68:71], v26 offset:64
    ds_read_b128 v[72:75], v26 offset:128
    ds_read_b128 v[76:79], v26 offset:192
    s_mov_b64 exec, -1
    ds_read_b64_tr_b16 v[128:129], v12 offset:8192
    ds_read_b64_tr_b16 v[130:131], v12 offset:8704
    ds_read_b64_tr_b16 v[132:133], v13 offset:8192
    ds_read_b64_tr_b16 v[134:135], v13 offset:8704
    ds_read_b64_tr_b16 v[136:137], v14 offset:8192
    ds_read_b64_tr_b16 v[138:139], v14 offset:8704
    ds_read_b64_tr_b16 v[140:141], v15 offset:8192
    ds_read_b64_tr_b16 v[142:143], v15 offset:8704
    v_mfma_f32_16x16x32_bf16 v[160:163], v[48:51], v[48:51], v[160:163]
    v_mfma_f32_16x16x32_bf16 v[160:163], v[52:55], v[52:55], v[160:163]
    v_mfma_f32_16x16x32_bf16 v[160:163], v[56:59], v[56:59], v[160:163]
    v_mfma_f32_16x16x32_bf16 v[160:163], v[60:63], v[60:63], v[160:163]
    v_mfma_f32_16x16x32_bf16 v[164:167], v[112:115], v[36:39], v[164:167]
    v_mfma_f32_16x16x32_bf16 v[168:171], v[116:119], v[36:39], v[168:171]
    v_mfma_f32_16x16x32_bf16 v[172:175], v[120:123], v[36:39], v[172:175]
    v_mfma_f32_16x16x32_bf16 v[176:179], v[124:127], v[36:39], v[176:179]
    s_waitcnt lgkmcnt(0)
    s_mov_b32 exec_lo, 0x000f000f
    s_mov_b32 exec_hi, 0x000f000f
    ds_read_b128 v[80:83], v27 offset:0
    ds_read_b128 v[84:87], v27 offset:64
    ds_read_b128 v[88:91], v27 offset:128
    ds_read_b128 v[92:95], v27 offset:192
    s_mov_b64 exec, -1
    ds_read_b64_tr_b16 v[144:145], v12 offset:12288
    ds_read_b64_tr_b16 v[146:147], v12 offset:12800
    ds_read_b64_tr_b16 v[148:149], v13 offset:12288
    ds_read_b64_tr_b16 v[150:151], v13 offset:12800
    ds_read_b64_tr_b16 v[152:153], v14 offset:12288
    ds_read_b64_tr_b16 v[154:155], v14 offset:12800
    ds_read_b64_tr_b16 v[156:157], v15 offset:12288
    ds_read_b64_tr_b16 v[158:159], v15 offset:12800
    v_mfma_f32_16x16x32_bf16 v[160:163], v[64:67], v[64:67], v[160:163]
    v_mfma_f32_16x16x32_bf16 v[160:163], v[68:71], v[68:71], v[160:163]
    v_mfma_f32_16x16x32_bf16 v[160:163], v[72:75], v[72:75], v[160:163]
    v_mfma_f32_16x16x32_bf16 v[160:163], v[76:79], v[76:79], v[160:163]
    v_mfma_f32_16x16x32_bf16 v[164:167], v[128:131], v[40:43], v[164:167]
    v_mfma_f32_16x16x32_bf16 v[168:171], v[132:135], v[40:43], v[168:171]
    v_mfma_f32_16x16x32_bf16 v[172:175], v[136:139], v[40:43], v[172:175]
    v_mfma_f32_16x16x32_bf16 v[176:179], v[140:143], v[40:43], v[176:179]
    s_waitcnt lgkmcnt(0)
    s_sub_u32 s60, s3, 1
    s_lshl_b32 s60, s60, 2
    v_add_u32 v18, s60, v21
    v_mov_b32 v19, 1
    ds_write_b32 v18, v19 offset:8
    v_mfma_f32_16x16x32_bf16 v[160:163], v[80:83], v[80:83], v[160:163]
    v_mfma_f32_16x16x32_bf16 v[160:163], v[84:87], v[84:87], v[160:163]
    v_mfma_f32_16x16x32_bf16 v[160:163], v[88:91], v[88:91], v[160:163]
    v_mfma_f32_16x16x32_bf16 v[160:163], v[92:95], v[92:95], v[160:163]
    s_nop 7
    ds_bpermute_b32 v19, v17, v160
    v_mfma_f32_16x16x32_bf16 v[164:167], v[144:147], v[44:47], v[164:167]
    v_mfma_f32_16x16x32_bf16 v[168:171], v[148:151], v[44:47], v[168:171]
    v_mfma_f32_16x16x32_bf16 v[172:175], v[152:155], v[44:47], v[172:175]
    v_mfma_f32_16x16x32_bf16 v[176:179], v[156:159], v[44:47], v[176:179]
    s_cmp_eq_u32 s3, 1
    s_cbranch_scc0 L_q2
    s_add_u32 s30, s30, 0x9e3779b9
L_q2:
    s_waitcnt lgkmcnt(0)
    v_mul_f32 v24, 0xbb000000, v19
    v_mov_b32 v98, s30
    v_mov_b32 v99, s63
    v_fmac_f32_dpp v164, v164, v24 row_shl:4 row_mask:0xf bank_mask:0xf bound_ctrl:1
    v_fmac_f32_dpp v165, v165, v24 row_shl:4 row_mask:0xf bank_mask:0xf bound_ctrl:1
    v_fmac_f32_dpp v166, v166, v24 row_shl:4 row_mask:0xf bank_mask:0xf bound_ctrl:1
    v_fmac_f32_dpp v167, v167, v24 row_shl:4 row_mask:0xf bank_mask:0xf bound_ctrl:1
    v_fmac_f32_dpp v168, v168, v24 row_shl:4 row_mask:0xf bank_mask:0xf bound_ctrl:1
    v_fmac_f32_dpp v169, v169, v24 row_shl:4 row_mask:0xf bank_mask:0xf bound_ctrl:1
    v_fmac_f32_dpp v170, v170, v24 row_shl:4 row_mask:0xf bank_mask:0xf bound_ctrl:1
    v_fmac_f32_dpp v171, v171, v24 row_shl:4 row_mask:0xf bank_mask:0xf bound_ctrl:1
    v_fmac_f32_dpp v172, v172, v24 row_shl:4 row_mask:0xf bank_mask:0xf bound_ctrl:1
    v_fmac_f32_dpp v173, v173, v24 row_shl:4 row_mask:0xf bank_mask:0xf bound_ctrl:1
    v_fmac_f32_dpp v174, v174, v24 row_shl:4 row_mask:0xf bank_mask:0xf bound_ctrl:1
    v_fmac_f32_dpp v175, v175, v24 row_shl:4 row_mask:0xf bank_mask:0xf bound_ctrl:1
    v_fmac_f32_dpp v176, v176, v24 row_shl:4 row_mask:0xf bank_mask:0xf bound_ctrl:1
    v_fmac_f32_dpp v177, v177, v24 row_shl:4 row_mask:0xf bank_mask:0xf bound_ctrl:1
    v_fmac_f32_dpp v178, v178, v24 row_shl:4 row_mask:0xf bank_mask:0xf bound_ctrl:1
    v_fmac_f32_dpp v179, v179, v24 row_shl:4 row_mask:0xf bank_mask:0xf bound_ctrl:1
    v_cvt_pk_bf16_f32 v96, v164, v165
    v_cvt_pk_bf16_f32 v97, v166, v167
    v_cvt_pk_bf16_f32 v168, v168, v169
    v_cvt_pk_bf16_f32 v169, v170, v171
    v_cvt_pk_bf16_f32 v172, v172, v173
    v_cvt_pk_bf16_f32 v173, v174, v175
    v_cvt_pk_bf16_f32 v176, v176, v177
    v_cvt_pk_bf16_f32 v177, v178, v179
    v_mov_b32_dpp v96, v168 row_shr:4 row_mask:0xf bank_mask:0x2
    v_mov_b32_dpp v97, v169 row_shr:4 row_mask:0xf bank_mask:0x2
    s_nop 0
    v_mov_b32_dpp v96, v172 row_shr:8 row_mask:0xf bank_mask:0x4
    v_mov_b32_dpp v97, v173 row_shr:8 row_mask:0xf bank_mask:0x4
    s_nop 0
    v_mov_b32_dpp v96, v176 row_shr:12 row_mask:0xf bank_mask:0x8
    v_mov_b32_dpp v97, v177 row_shr:12 row_mask:0xf bank_mask:0x8
    s_cmp_eq_u32 s3, 1
    s_cbranch_scc1 L_qnear
    buffer_store_dwordx4 v[96:99], v16, s[40:43], s73 offen sc1
    s_endpgm
L_qnear:
    buffer_store_dwordx4 v[96:99], v16, s[40:43], s73 offen
    v_cmp_eq_u32 vcc, 1, v3
    s_nop 1
    v_cndmask_b32 v18, v160, v161, vcc
    v_cmp_eq_u32 vcc, 2, v3
    s_nop 1
    v_cndmask_b32 v18, v18, v162, vcc
    v_cmp_eq_u32 vcc, 3, v3
    s_nop 1
    v_cndmask_b32 v18, v18, v163, vcc
    s_mov_b32 s61, 0x3727c5ac
    v_mul_f32 v18, 0x3b000000, v18
    v_fma_f32 v18, -v24, v24, v18
    v_max_f32 v18, 0, v18
    v_add_f32 v26, s61, v18
    v_rsq_f32 v26, v26
    v_lshlrev_b32 v10, 3, v0
    v_mul_f32 v27, v26, v26
    v_fma_f32 v27, v27, v18, s61
    v_rsq_f32 v27, v27
    v_add_u32 v11, 147520, v10
    v_add_u32 v10, 148480, v10
    v_mul_f32 v27, v26, v27
    v_mul_f32 v26, 0x3e0293ee, v26
    s_mov_b64 exec, 15
    ds_write_b64 v11, v[26:27]
    s_mov_b64 exec, -1
    s_lshl_b32 s62, s53, 13
    s_add_u32 s62, s62, 65536
    s_add_u32 s61, s62, 4096
    s_mov_b32 s58, 0x3f80
    s_mov_b32 s59, 0x3f800000
L_lw4:
    ds_read_b32 v20, v21 offset:0
    s_waitcnt lgkmcnt(0)
    v_readfirstlane_b32 s56, v20
    s_nop 0
    s_cmp_ge_i32 s56, 7
    s_cbranch_scc1 L_lw4_ok
    s_sleep 2
    s_sub_u32 s71, s71, 1
    s_cbranch_scc0 L_lw4
    s_endpgm
L_lw4_ok:
    s_mov_b32 s31, 131071
L_pq:
    buffer_load_dwordx4 v[100:103], v29, s[40:43], s62 offen offset:0 sc1
    buffer_load_dwordx4 v[104:107], v29, s[40:43], s62 offen offset:1024 sc1
    buffer_load_dwordx4 v[108:111], v29, s[40:43], s62 offen offset:2048 sc1
    buffer_load_dwordx4 v[112:115], v29, s[40:43], s62 offen offset:3072 sc1
    buffer_load_dwordx4 v[116:119], v29, s[40:43], s61 offen offset:0 sc1
    buffer_load_dwordx4 v[120:123], v29, s[40:43], s61 offen offset:1024 sc1
    buffer_load_dwordx4 v[124:127], v29, s[40:43], s61 offen offset:2048 sc1
    buffer_load_dwordx4 v[128:131], v29, s[40:43], s61 offen offset:3072 sc1
    s_waitcnt vmcnt(0)
    v_cmpx_eq_u32 vcc, s30, v102
    v_cmpx_eq_u32 vcc, s30, v106
    v_cmpx_eq_u32 vcc, s30, v110
    v_cmpx_eq_u32 vcc, s30, v114
    v_cmpx_eq_u32 vcc, s30, v118
    v_cmpx_eq_u32 vcc, s30, v122
    v_cmpx_eq_u32 vcc, s30, v126
    v_cmpx_eq_u32 vcc, s30, v130
    s_nop 1
    s_cmp_eq_u64 exec, -1
    s_mov_b64 exec, -1
    s_cbranch_scc1 L_pq_ok
    s_cmp_eq_u32 s31, 131069
    s_cbranch_scc0 L_pq_n
    buffer_store_dwordx4 v[96:99], v16, s[40:43], s73 offen sc1
L_pq_n:
    s_sub_u32 s31, s31, 1
    s_cbranch_scc0 L_pq
L_pq_ok:
    v_dot2_f32_bf16 v132, v100, s58, 0
    v_dot2_f32_bf16 v133, v100, s59, 0
    v_dot2_f32_bf16 v134, v101, s58, 0
    v_dot2_f32_bf16 v135, v101, s59, 0
    v_dot2_f32_bf16 v136, v104, s58, 0
    v_dot2_f32_bf16 v137, v104, s59, 0
    v_dot2_f32_bf16 v138, v105, s58, 0
    v_dot2_f32_bf16 v139, v105, s59, 0
    v_dot2_f32_bf16 v132, v108, s58, v132
    v_dot2_f32_bf16 v133, v108, s59, v133
    v_dot2_f32_bf16 v134, v109, s58, v134
    v_dot2_f32_bf16 v135, v109, s59, v135
    v_dot2_f32_bf16 v136, v112, s58, v136
    v_dot2_f32_bf16 v137, v112, s59, v137
    v_dot2_f32_bf16 v138, v113, s58, v138
    v_dot2_f32_bf16 v139, v113, s59, v139
    v_dot2_f32_bf16 v132, v116, s58, v132
    v_dot2_f32_bf16 v133, v116, s59, v133
    v_dot2_f32_bf16 v134, v117, s58, v134
    v_dot2_f32_bf16 v135, v117, s59, v135
    v_dot2_f32_bf16 v136, v120, s58, v136
    v_dot2_f32_bf16 v137, v120, s59, v137
    v_dot2_f32_bf16 v138, v121, s58, v138
    v_dot2_f32_bf16 v139, v121, s59, v139
    v_dot2_f32_bf16 v132, v124, s58, v132
    v_dot2_f32_bf16 v133, v124, s59, v133
    v_dot2_f32_bf16 v134, v125, s58, v134
    v_dot2_f32_bf16 v135, v125, s59, v135
    v_dot2_f32_bf16 v136, v128, s58, v136
    v_dot2_f32_bf16 v137, v128, s59, v137
    v_dot2_f32_bf16 v138, v129, s58, v138
    v_dot2_f32_bf16 v139, v129, s59, v139
    v_cvt_pk_bf16_f32 v132, v132, v133
    v_cvt_pk_bf16_f32 v133, v134, v135
    v_cvt_pk_bf16_f32 v134, v136, v137
    v_cvt_pk_bf16_f32 v135, v138, v139
    ds_write_b64 v10, v[132:133]
    ds_write_b64 v10, v[134:135] offset:512
    v_cmpx_eq_u32 vcc, s63, v103
    v_cmpx_eq_u32 vcc, s63, v107
    v_cmpx_eq_u32 vcc, s63, v111
    v_cmpx_eq_u32 vcc, s63, v115
    v_cmpx_eq_u32 vcc, s63, v119
    v_cmpx_eq_u32 vcc, s63, v123
    v_cmpx_eq_u32 vcc, s63, v127
    v_cmpx_eq_u32 vcc, s63, v131
    s_nop 1
    s_cmp_eq_u64 exec, -1
    s_mov_b64 exec, -1
    s_cselect_b32 s72, 1, 0
    s_cbranch_scc1 L_qloc
    buffer_store_dwordx4 v[96:99], v16, s[40:43], s73 offen sc1
L_qloc:
    v_mov_b32 v26, s30
    v_mov_b32 v27, s72
    ds_write_b64 v21, v[26:27] offset:48
    v_mov_b32 v20, 1
    ds_write_b32 v21, v20 offset:4
    s_cmp_lt_u32 s52, 4
    s_cbranch_scc1 L_hash
    s_sub_u32 s58, s52, 4
    s_lshl_b32 s58, s58, 5
    s_add_u32 s58, s58, s53
    s_cmp_ge_u32 s58, 112
    s_cbranch_scc1 L_noh
    s_and_b32 s57, s58, 3
    s_lshr_b32 s58, s58, 2
    s_branch L_hash
L_noh:
    v_mov_b32 v20, 1
    ds_write_b32 v21, v20 offset:12
L_hash:
    s_cmp_lt_u32 s52, 2
    s_cbranch_scc0 L_fin
    s_mov_b32 s44, s22
    s_mov_b32 s45, s23
    s_mov_b32 s46, 1024
    s_mov_b32 s47, 0x20000
    s_mov_b32 s48, s4
    s_mov_b32 s49, s5
    s_mov_b32 s50, 4096
    s_mov_b32 s51, 0x20000
    s_lshl_b32 s57, s54, 1
    s_add_u32 s57, s57, s52
    s_lshl_b32 s58, s55, 4
    s_add_u32 s58, s58, s57
    s_lshl_b32 s65, s58, 6
    s_lshl_b32 s57, s57, 6
    s_mov_b32 s74, 0x3f80
    s_mov_b32 s75, 0x3f800000
    buffer_load_ushort v28, v1, s[44:47], s57 offen
    buffer_load_ushort v4, v1, s[48:51], s65 offen
    s_lshl_b32 s64, s58, 12
    s_lshr_b32 s60, s64, 1
    s_add_u32 s60, s60, 524288
L_lw5:
    ds_read_b32 v20, v21 offset:0
    s_waitcnt lgkmcnt(0)
    v_readfirstlane_b32 s56, v20
    s_nop 0
    s_cmp_ge_i32 s56, 48
    s_cbranch_scc1 L_lw5_ok
    s_sleep 16
    s_sub_u32 s71, s71, 1
    s_cbranch_scc0 L_lw5
    s_endpgm
L_lw5_ok:
    s_mov_b32 s31, 131071
L_pm:
    buffer_load_dwordx4 v[96:99], v29, s[40:43], s60 offen offset:0 sc1
    buffer_load_dwordx4 v[100:103], v29, s[40:43], s60 offen offset:1024 sc1
    s_waitcnt vmcnt(0)
    v_cmpx_eq_u32 vcc, s30, v97
    v_cmpx_eq_u32 vcc, s30, v99
    v_cmpx_eq_u32 vcc, s30, v101
    v_cmpx_eq_u32 vcc, s30, v103
    s_nop 1
    s_cmp_eq_u64 exec, -1
    s_mov_b64 exec, -1
    s_cbranch_scc1 L_pm_ok
    s_sleep 8
    s_sub_u32 s31, s31, 1
    s_cbranch_scc0 L_pm
L_pm_ok:
    v_dot2_f32_bf16 v112, v96, s74, 0
    v_dot2_f32_bf16 v113, v96, s75, 0
    v_dot2_f32_bf16 v114, v98, s74, 0
    v_dot2_f32_bf16 v115, v98, s75, 0
    v_dot2_f32_bf16 v112, v100, s74, v112
    v_dot2_f32_bf16 v113, v100, s75, v113
    v_dot2_f32_bf16 v114, v102, s74, v114
    v_dot2_f32_bf16 v115, v102, s75, v115
    s_nop 1
    s_call_b64 s[62:63], L_pg_ok
    s_waitcnt vmcnt(0)
    v_lshlrev_b32 v28, 16, v28
    v_lshlrev_b32 v4, 16, v4
    v_add_f32 v28, v28, v112
    v_mul_f32 v10, 0xbfb8aa3b, v28
    v_exp_f32 v10, v10
    s_add_u32 s60, s64, 1572864
    v_add_f32 v10, 1.0, v10
    v_rcp_f32 v10, v10
    v_mov_b32 v25, s30
    v_mul_f32 v28, v28, v10
    s_mov_b32 s44, s24
    s_mov_b32 s45, s25
    s_mov_b32 s46, 4096
    s_mov_b32 s47, 0x20000
    s_mov_b64 exec, 0
    s_branch Lpad_F_0
Lret_F:
    s_mov_b64 exec, -1
    s_barrier
    s_barrier
    s_barrier
    s_call_b64 s[62:63], L_gather
    v_fma_f32 v28, v28, v112, v4
    v_cvt_pk_bf16_f32 v28, v28, v28
    s_mov_b32 exec_lo, 0x00ff00ff
    s_mov_b32 exec_hi, 0x00ff00ff
    buffer_store_short v28, v1, s[44:47], s65 offen
Lpad_F_0:
    s_cbranch_execz Lpad_F_1
    s_cmp_eq_u32 s2, 0
    s_cbranch_scc0 L_fin
    v_mov_b32 v10, 0
    s_mov_b64 exec, 1
    buffer_store_dword v25, v10, s[40:43], 0 offen sc1
L_fin:
L_end:
    s_endpgm
L_A1:
    s_sub_u32 s58, s52, 4
    s_lshl_b32 s58, s58, 5
    s_add_u32 s58, s58, s53
    s_cmp_ge_u32 s58, 112
    s_cbranch_scc1 L_fin
    s_and_b32 s57, s58, 3
    s_lshr_b32 s58, s58, 2
L_lw6:
    ds_read_b32 v20, v21 offset:4
    s_waitcnt lgkmcnt(0)
    v_readfirstlane_b32 s56, v20
    s_nop 0
    s_cmp_ge_i32 s56, 1
    s_cbranch_scc1 L_lw6_ok
    s_sleep 8
    s_sub_u32 s71, s71, 1
    s_cbranch_scc0 L_lw6
    s_endpgm
L_lw6_ok:
    ds_read_b64 v[22:23], v21 offset:48
    s_waitcnt lgkmcnt(0)
    v_readfirstlane_b32 s30, v22
    v_readfirstlane_b32 s72, v23
    s_mov_b32 s59, 10
    s_branch L_qh
L_A2:
    s_cmp_lt_u32 s52, 4
    s_cbranch_scc0 L_fin
    s_mov_b32 s44, s18
    s_mov_b32 s45, s19
    s_mov_b32 s46, 3584
    s_mov_b32 s47, 0x20000
    s_lshl_b32 s66, s55, 2
    s_add_u32 s66, s66, s52
    s_mul_i32 s57, s66, 224
    buffer_load_dwordx2 v[24:25], v30, s[44:47], s57 offen
    buffer_load_dwordx2 v[26:27], v30, s[44:47], s57 offen offset:128
    v_mov_b32 v11, 7168
    v_lshlrev_b32 v10, 4, v3
    v_mad_u32_u24 v10, v2, v11, v10
    v_min_u32 v16, 11, v3
    v_lshlrev_b32 v16, 4, v16
    v_mad_u32_u24 v11, v2, v11, v16
    s_lshl_b32 s57, s57, 1
    s_add_u32 s57, s57, 327680
    s_add_u32 s58, s57, 28672
    s_add_u32 s59, s58, 28672
    s_add_u32 s60, s59, 28672
    v_add_u32 v12, 131072, v7
    v_xor_b32 v13, 32, v12
    v_xor_b32 v14, 64, v12
    v_xor_b32 v15, 0x60, v12
L_lw7:
    ds_read_b32 v20, v21 offset:4
    s_waitcnt lgkmcnt(0)
    v_readfirstlane_b32 s56, v20
    s_nop 0
    s_cmp_ge_i32 s56, 1
    s_cbranch_scc1 L_lw7_ok
    s_sleep 8
    s_sub_u32 s71, s71, 1
    s_cbranch_scc0 L_lw7
    s_endpgm
L_lw7_ok:
    ds_read_b64 v[22:23], v21 offset:48
    s_waitcnt lgkmcnt(0)
    v_readfirstlane_b32 s30, v22
    v_readfirstlane_b32 s72, v23
L_lw8:
    ds_read_b32 v20, v21 offset:0
    s_waitcnt lgkmcnt(0)
    v_readfirstlane_b32 s56, v20
    s_nop 0
    s_cmp_ge_i32 s56, 10
    s_cbranch_scc1 L_lw8_ok
    s_sleep 8
    s_sub_u32 s71, s71, 1
    s_cbranch_scc0 L_lw8
    s_endpgm
L_lw8_ok:
    ds_read_b64_tr_b16 v[96:97], v12 offset:0
    ds_read_b64_tr_b16 v[98:99], v12 offset:512
    ds_read_b64_tr_b16 v[100:101], v13 offset:0
    ds_read_b64_tr_b16 v[102:103], v13 offset:512
    ds_read_b64_tr_b16 v[104:105], v14 offset:0
    ds_read_b64_tr_b16 v[106:107], v14 offset:512
    ds_read_b64_tr_b16 v[108:109], v15 offset:0
    ds_read_b64_tr_b16 v[110:111], v15 offset:512
    ds_read_b64_tr_b16 v[112:113], v12 offset:4096
    ds_read_b64_tr_b16 v[114:115], v12 offset:4608
    ds_read_b64_tr_b16 v[116:117], v13 offset:4096
    ds_read_b64_tr_b16 v[118:119], v13 offset:4608
    ds_read_b64_tr_b16 v[120:121], v14 offset:4096
    ds_read_b64_tr_b16 v[122:123], v14 offset:4608
    s_waitcnt lgkmcnt(12)
    ds_read_b64_tr_b16 v[124:125], v15 offset:4096
    ds_read_b64_tr_b16 v[126:127], v15 offset:4608
    s_waitcnt lgkmcnt(12)
    ds_read_b64_tr_b16 v[128:129], v12 offset:8192
    ds_read_b64_tr_b16 v[130:131], v12 offset:8704
    s_waitcnt lgkmcnt(12)
    ds_read_b64_tr_b16 v[132:133], v13 offset:8192
    ds_read_b64_tr_b16 v[134:135], v13 offset:8704
    s_waitcnt lgkmcnt(12)
    ds_read_b64_tr_b16 v[136:137], v14 offset:8192
    ds_read_b64_tr_b16 v[138:139], v14 offset:8704
    s_waitcnt lgkmcnt(12)
    ds_read_b64_tr_b16 v[140:141], v15 offset:8192
    ds_read_b64_tr_b16 v[142:143], v15 offset:8704
    s_waitcnt lgkmcnt(12)
    ds_read_b64_tr_b16 v[144:145], v12 offset:12288
    ds_read_b64_tr_b16 v[146:147], v12 offset:12800
    s_waitcnt lgkmcnt(12)
    ds_read_b64_tr_b16 v[148:149], v13 offset:12288
    ds_read_b64_tr_b16 v[150:151], v13 offset:12800
    s_waitcnt lgkmcnt(12)
    ds_read_b64_tr_b16 v[152:153], v14 offset:12288
    ds_read_b64_tr_b16 v[154:155], v14 offset:12800
    s_waitcnt lgkmcnt(12)
    ds_read_b64_tr_b16 v[156:157], v15 offset:12288
    ds_read_b64_tr_b16 v[158:159], v15 offset:12800
    v_lshlrev_b32 v28, 3, v2
    v_add_u32 v28, 147524, v28
    ds_read_b32 v28, v28
    s_waitcnt lgkmcnt(0)
    v_mov_b32 v20, 1
    ds_write_b32 v21, v20 offset:12
L_lw9:
    ds_read_b32 v20, v21 offset:0
    s_waitcnt lgkmcnt(0)
    v_readfirstlane_b32 s56, v20
    s_nop 0
    s_cmp_ge_i32 s56, 34
    s_cbranch_scc1 L_lw9_ok
    s_sleep 16
    s_sub_u32 s71, s71, 1
    s_cbranch_scc0 L_lw9
    s_endpgm
L_lw9_ok:
    s_mov_b32 s31, 131071
L_ph:
    buffer_load_dwordx4 v[32:35], v10, s[40:43], s57 offen offset:0 sc1
    buffer_load_dwordx4 v[36:39], v10, s[40:43], s58 offen offset:0 sc1
    buffer_load_dwordx4 v[40:43], v10, s[40:43], s59 offen offset:0 sc1
    buffer_load_dwordx4 v[44:47], v10, s[40:43], s60 offen offset:0 sc1
    buffer_load_dwordx4 v[48:51], v11, s[40:43], s57 offen offset:256 sc1
    buffer_load_dwordx4 v[52:55], v11, s[40:43], s58 offen offset:256 sc1
    buffer_load_dwordx4 v[56:59], v11, s[40:43], s59 offen offset:256 sc1
    buffer_load_dwordx4 v[60:63], v11, s[40:43], s60 offen offset:256 sc1
    s_waitcnt vmcnt(0)
    v_cmpx_eq_u32 vcc, s30, v34
    v_cmpx_eq_u32 vcc, s30, v38
    v_cmpx_eq_u32 vcc, s30, v42
    v_cmpx_eq_u32 vcc, s30, v46
    v_cmpx_eq_u32 vcc, s30, v50
    v_cmpx_eq_u32 vcc, s30, v54
    v_cmpx_eq_u32 vcc, s30, v58
    v_cmpx_eq_u32 vcc, s30, v62
    s_nop 1
    s_cmp_eq_u64 exec, -1
    s_mov_b64 exec, -1
    s_cbranch_scc1 L_ph_ok
    s_sleep 8
    s_sub_u32 s31, s31, 1
    s_cbranch_scc0 L_ph
L_ph_ok:
    s_mov_b32 s58, 0x3f80
    s_mov_b32 s59, 0x3f800000
    v_dot2_f32_bf16 v72, v24, s58, 0
    v_dot2_f32_bf16 v73, v24, s59, 0
    v_dot2_f32_bf16 v74, v25, s58, 0
    v_dot2_f32_bf16 v75, v25, s59, 0
    v_dot2_f32_bf16 v76, v26, s58, 0
    v_dot2_f32_bf16 v77, v26, s59, 0
    v_dot2_f32_bf16 v78, v27, s58, 0
    v_dot2_f32_bf16 v79, v27, s59, 0
    v_dot2_f32_bf16 v64, v32, s58, 0
    v_dot2_f32_bf16 v65, v32, s59, 0
    v_dot2_f32_bf16 v66, v33, s58, 0
    v_dot2_f32_bf16 v67, v33, s59, 0
    v_dot2_f32_bf16 v68, v48, s58, 0
    v_dot2_f32_bf16 v69, v48, s59, 0
    v_dot2_f32_bf16 v70, v49, s58, 0
    v_dot2_f32_bf16 v71, v49, s59, 0
    v_dot2_f32_bf16 v64, v36, s58, v64
    v_dot2_f32_bf16 v65, v36, s59, v65
    v_dot2_f32_bf16 v66, v37, s58, v66
    v_dot2_f32_bf16 v67, v37, s59, v67
    v_dot2_f32_bf16 v68, v52, s58, v68
    v_dot2_f32_bf16 v69, v52, s59, v69
    v_dot2_f32_bf16 v70, v53, s58, v70
    v_dot2_f32_bf16 v71, v53, s59, v71
    v_dot2_f32_bf16 v64, v40, s58, v64
    v_dot2_f32_bf16 v65, v40, s59, v65
    v_dot2_f32_bf16 v66, v41, s58, v66
    v_dot2_f32_bf16 v67, v41, s59, v67
    v_dot2_f32_bf16 v68, v56, s58, v68
    v_dot2_f32_bf16 v69, v56, s59, v69
    v_dot2_f32_bf16 v70, v57, s58, v70
    v_dot2_f32_bf16 v71, v57, s59, v71
    v_dot2_f32_bf16 v64, v44, s58, v64
    v_dot2_f32_bf16 v65, v44, s59, v65
    v_dot2_f32_bf16 v66, v45, s58, v66
    v_dot2_f32_bf16 v67, v45, s59, v67
    v_dot2_f32_bf16 v68, v60, s58, v68
    v_dot2_f32_bf16 v69, v60, s59, v69
    v_dot2_f32_bf16 v70, v61, s58, v70
    v_dot2_f32_bf16 v71, v61, s59, v71
    v_fma_f32 v64, v64, v28, v72
    v_fma_f32 v65, v65, v28, v73
    v_fma_f32 v66, v66, v28, v74
    v_fma_f32 v67, v67, v28, v75
    v_fma_f32 v68, v68, v28, v76
    v_fma_f32 v69, v69, v28, v77
    v_fma_f32 v70, v70, v28, v78
    v_fma_f32 v71, v71, v28, v79
    s_mov_b32 s58, 0xbdd2d3e8
    v_mov_b32 v28, 0xc0135761
    v_mul_f32 v72, v64, v64
    v_mul_f32 v73, v65, v65
    v_mul_f32 v74, v66, v66
    v_mul_f32 v75, v67, v67
    v_mul_f32 v76, v68, v68
    v_mul_f32 v77, v69, v69
    v_mul_f32 v78, v70, v70
    v_mul_f32 v79, v71, v71
    v_fma_f32 v72, v72, s58, v28
    v_fma_f32 v73, v73, s58, v28
    v_fma_f32 v74, v74, s58, v28
    v_fma_f32 v75, v75, s58, v28
    v_fma_f32 v76, v76, s58, v28
    v_fma_f32 v77, v77, s58, v28
    v_fma_f32 v78, v78, s58, v28
    v_fma_f32 v79, v79, s58, v28
    v_mul_f32 v72, v72, v64
    v_mul_f32 v73, v73, v65
    v_mul_f32 v74, v74, v66
    v_mul_f32 v75, v75, v67
    v_mul_f32 v76, v76, v68
    v_mul_f32 v77, v77, v69
    v_mul_f32 v78, v78, v70
    v_mul_f32 v79, v79, v71
    v_exp_f32 v72, v72
    v_exp_f32 v73, v73
    v_exp_f32 v74, v74
    v_exp_f32 v75, v75
    v_exp_f32 v76, v76
    v_exp_f32 v77, v77
    v_exp_f32 v78, v78
    v_exp_f32 v79, v79
    v_add_f32 v72, 1.0, v72
    v_add_f32 v73, 1.0, v73
    v_add_f32 v74, 1.0, v74
    v_add_f32 v75, 1.0, v75
    v_add_f32 v76, 1.0, v76
    v_add_f32 v77, 1.0, v77
    v_add_f32 v78, 1.0, v78
    v_add_f32 v79, 1.0, v79
    v_rcp_f32 v72, v72
    v_rcp_f32 v73, v73
    v_rcp_f32 v74, v74
    v_rcp_f32 v75, v75
    v_rcp_f32 v76, v76
    v_rcp_f32 v77, v77
    v_rcp_f32 v78, v78
    v_rcp_f32 v79, v79
    v_mul_f32 v64, v64, v72
    v_mul_f32 v65, v65, v73
    v_mul_f32 v66, v66, v74
    v_mul_f32 v67, v67, v75
    v_mul_f32 v68, v68, v76
    v_mul_f32 v69, v69, v77
    v_mul_f32 v70, v70, v78
    v_mul_f32 v71, v71, v79
    v_cvt_pk_bf16_f32 v64, v64, v65
    v_cvt_pk_bf16_f32 v65, v66, v67
    v_cvt_pk_bf16_f32 v66, v68, v69
    v_cvt_pk_bf16_f32 v67, v70, v71
    v_cmp_gt_u32 vcc, 12, v3
    v_lshl_add_u32 v10, v2, 8, v30
    v_add_u32 v10, 149504, v10
    v_cndmask_b32 v66, 0, v66, vcc
    v_cndmask_b32 v67, 0, v67, vcc
    v_and_b32 v11, 3, v0
    v_lshlrev_b32 v11, 8, v11
    v_lshl_add_u32 v11, v2, 4, v11
    v_add_u32 v11, 149504, v11
    ds_write_b64 v10, v[64:65]
    ds_write_b64 v10, v[66:67] offset:128
    ds_read_b128 v[32:35], v11 offset:0
    ds_read_b128 v[36:39], v11 offset:64
    ds_read_b128 v[40:43], v11 offset:128
    ds_read_b128 v[44:47], v11 offset:192
    s_lshl_b32 s57, s54, 12
    s_lshl_b32 s58, s66, 7
    s_add_u32 s57, s57, s58
    s_add_u32 s57, s57, 524288
    v_lshlrev_b32 v31, 2, v3
    v_and_b32 v16, 1, v2
    v_lshl_add_u32 v31, v16, 6, v31
    v_lshrrev_b32 v16, 1, v2
    v_lshl_add_u32 v31, v16, 11, v31
    s_waitcnt lgkmcnt(0)
    v_mfma_f32_16x16x32_bf16 v[160:163], v[32:35], v[96:99], 0
    v_mfma_f32_16x16x32_bf16 v[164:167], v[32:35], v[100:103], 0
    v_mfma_f32_16x16x32_bf16 v[168:171], v[32:35], v[104:107], 0
    v_mfma_f32_16x16x32_bf16 v[172:175], v[32:35], v[108:111], 0
    v_mfma_f32_16x16x32_bf16 v[160:163], v[36:39], v[112:115], v[160:163]
    v_mfma_f32_16x16x32_bf16 v[164:167], v[36:39], v[116:119], v[164:167]
    v_mfma_f32_16x16x32_bf16 v[168:171], v[36:39], v[120:123], v[168:171]
    v_mfma_f32_16x16x32_bf16 v[172:175], v[36:39], v[124:127], v[172:175]
    v_mfma_f32_16x16x32_bf16 v[160:163], v[40:43], v[128:131], v[160:163]
    v_mfma_f32_16x16x32_bf16 v[164:167], v[40:43], v[132:135], v[164:167]
    v_mfma_f32_16x16x32_bf16 v[168:171], v[40:43], v[136:139], v[168:171]
    v_mfma_f32_16x16x32_bf16 v[172:175], v[40:43], v[140:143], v[172:175]
    v_mfma_f32_16x16x32_bf16 v[160:163], v[44:47], v[144:147], v[160:163]
    v_mfma_f32_16x16x32_bf16 v[164:167], v[44:47], v[148:151], v[164:167]
    v_mfma_f32_16x16x32_bf16 v[168:171], v[44:47], v[152:155], v[168:171]
    v_mfma_f32_16x16x32_bf16 v[172:175], v[44:47], v[156:159], v[172:175]
    v_mov_b32 v65, s30
    v_mov_b32 v67, s30
    v_mov_b32 v69, s30
    v_mov_b32 v71, s30
    s_nop 0
    v_mov_b32 v64, v160
    v_mov_b32 v66, v161
    v_mov_b32 v68, v162
    v_mov_b32 v70, v163
    v_mov_b32_dpp v64, v164 quad_perm:[0,1,2,3] row_mask:0x2 bank_mask:0xf
    v_mov_b32_dpp v66, v165 quad_perm:[0,1,2,3] row_mask:0x2 bank_mask:0xf
    v_mov_b32_dpp v68, v166 quad_perm:[0,1,2,3] row_mask:0x2 bank_mask:0xf
    v_mov_b32_dpp v70, v167 quad_perm:[0,1,2,3] row_mask:0x2 bank_mask:0xf
    v_mov_b32_dpp v64, v168 quad_perm:[0,1,2,3] row_mask:0x4 bank_mask:0xf
    v_mov_b32_dpp v66, v169 quad_perm:[0,1,2,3] row_mask:0x4 bank_mask:0xf
    v_mov_b32_dpp v68, v170 quad_perm:[0,1,2,3] row_mask:0x4 bank_mask:0xf
    v_mov_b32_dpp v70, v171 quad_perm:[0,1,2,3] row_mask:0x4 bank_mask:0xf
    v_mov_b32_dpp v64, v172 quad_perm:[0,1,2,3] row_mask:0x8 bank_mask:0xf
    v_mov_b32_dpp v66, v173 quad_perm:[0,1,2,3] row_mask:0x8 bank_mask:0xf
    v_mov_b32_dpp v68, v174 quad_perm:[0,1,2,3] row_mask:0x8 bank_mask:0xf
    v_mov_b32_dpp v70, v175 quad_perm:[0,1,2,3] row_mask:0x8 bank_mask:0xf
    v_mov_b32_dpp v72, v64 quad_perm:[1,0,3,2] row_mask:0xf bank_mask:0xf
    v_mov_b32_dpp v73, v66 quad_perm:[1,0,3,2] row_mask:0xf bank_mask:0xf
    v_mov_b32_dpp v74, v68 quad_perm:[1,0,3,2] row_mask:0xf bank_mask:0xf
    v_mov_b32_dpp v75, v70 quad_perm:[1,0,3,2] row_mask:0xf bank_mask:0xf
    v_cvt_pk_bf16_f32 v64, v64, v72
    v_cvt_pk_bf16_f32 v66, v66, v73
    v_cvt_pk_bf16_f32 v68, v68, v74
    v_cvt_pk_bf16_f32 v70, v70, v75
    s_mov_b32 exec_lo, 0x55555555
    s_mov_b32 exec_hi, 0x55555555
    s_cmp_eq_u32 s72, 1
    s_cbranch_scc0 L_mfar
    buffer_store_dwordx2 v[64:65], v31, s[40:43], s57 offen
    s_add_u32 s57, s57, 32768
    buffer_store_dwordx2 v[66:67], v31, s[40:43], s57 offen
    s_add_u32 s57, s57, 32768
    buffer_store_dwordx2 v[68:69], v31, s[40:43], s57 offen
    s_add_u32 s57, s57, 32768
    buffer_store_dwordx2 v[70:71], v31, s[40:43], s57 offen
    s_branch L_fin
L_mfar:
    buffer_store_dwordx2 v[64:65], v31, s[40:43], s57 offen sc1
    s_add_u32 s57, s57, 32768
    buffer_store_dwordx2 v[66:67], v31, s[40:43], s57 offen sc1
    s_add_u32 s57, s57, 32768
    buffer_store_dwordx2 v[68:69], v31, s[40:43], s57 offen sc1
    s_add_u32 s57, s57, 32768
    buffer_store_dwordx2 v[70:71], v31, s[40:43], s57 offen sc1
    s_branch L_fin
L_gather:
Lpad_F_1:
    s_cbranch_execz Lpad_F_2
    s_mov_b32 s31, 131071
L_pg:
    buffer_load_dwordx4 v[96:99], v29, s[40:43], s60 offen offset:0 sc1
    buffer_load_dwordx4 v[100:103], v29, s[40:43], s60 offen offset:1024 sc1
    buffer_load_dwordx4 v[104:107], v29, s[40:43], s60 offen offset:2048 sc1
    buffer_load_dwordx4 v[108:111], v29, s[40:43], s60 offen offset:3072 sc1
    s_waitcnt vmcnt(0)
    v_cmpx_eq_u32 vcc, s30, v97
    v_cmpx_eq_u32 vcc, s30, v99
    v_cmpx_eq_u32 vcc, s30, v101
    v_cmpx_eq_u32 vcc, s30, v103
    v_cmpx_eq_u32 vcc, s30, v105
    v_cmpx_eq_u32 vcc, s30, v107
    v_cmpx_eq_u32 vcc, s30, v109
    v_cmpx_eq_u32 vcc, s30, v111
    s_nop 1
    s_cmp_eq_u64 exec, -1
    s_mov_b64 exec, -1
    s_cbranch_scc1 L_pg_ok0
Lpad_F_2:
    s_cbranch_execz Lpad_F_3
    s_sub_u32 s31, s31, 1
    s_cbranch_scc0 L_pg
L_pg_ok0:
Lpad_F_3:
    s_cbranch_execz Lret_F
    v_dot2_f32_bf16 v112, v96, s74, 0
    v_dot2_f32_bf16 v113, v96, s75, 0
    v_dot2_f32_bf16 v114, v98, s74, 0
    v_dot2_f32_bf16 v115, v98, s75, 0
    v_dot2_f32_bf16 v112, v100, s74, v112
    v_dot2_f32_bf16 v113, v100, s75, v113
    v_dot2_f32_bf16 v114, v102, s74, v114
    v_dot2_f32_bf16 v115, v102, s75, v115
    v_dot2_f32_bf16 v112, v104, s74, v112
    v_dot2_f32_bf16 v113, v104, s75, v113
    v_dot2_f32_bf16 v114, v106, s74, v114
    v_dot2_f32_bf16 v115, v106, s75, v115
    v_dot2_f32_bf16 v112, v108, s74, v112
    v_dot2_f32_bf16 v113, v108, s75, v113
    v_dot2_f32_bf16 v114, v110, s74, v114
    v_dot2_f32_bf16 v115, v110, s75, v115
    s_nop 0
L_pg_ok:
    v_add_f32_dpp v112, v112, v112 row_ror:8 row_mask:0xf bank_mask:0xf
    v_add_f32_dpp v113, v113, v113 row_ror:8 row_mask:0xf bank_mask:0xf
    v_add_f32_dpp v114, v114, v114 row_ror:8 row_mask:0xf bank_mask:0xf
    v_add_f32_dpp v115, v115, v115 row_ror:8 row_mask:0xf bank_mask:0xf
    v_permlane16_swap_b32 v112, v113
    s_nop 0
    v_permlane16_swap_b32 v114, v115
    v_add_f32 v112, v112, v113
    v_add_f32 v114, v114, v115
    s_nop 1
    v_permlane32_swap_b32 v112, v114
    v_add_f32 v112, v112, v114
    s_setpc_b64 s[62:63]
L_C:
    s_sub_u32 s47, s3, 4
    v_and_b32 v10, 1, v2
    v_bfe_u32 v7, v0, 3, 1
    v_lshl_add_u32 v7, v10, 1, v7
    v_lshlrev_b32 v7, 5, v7
    v_and_b32 v10, 3, v0
    v_lshl_add_u32 v7, v10, 3, v7
    v_bfe_u32 v10, v0, 2, 2
    v_lshl_add_u32 v7, v10, 7, v7
    v_lshl_add_u32 v7, v2, 10, v7
    v_add_u32 v12, 131072, v7
    v_xor_b32 v13, 32, v12
    v_xor_b32 v14, 64, v12
    v_xor_b32 v15, 0x60, v12
    v_and_b32 v16, 7, v3
    v_lshlrev_b32 v16, 1, v16
    v_lshrrev_b32 v17, 3, v3
    v_or_b32 v16, v16, v17
    v_lshlrev_b32 v17, 2, v2
    v_xor_b32 v16, v16, v17
    v_lshlrev_b32 v16, 4, v16
    v_lshl_add_u32 v16, v3, 8, v16
    s_lshl_b32 s57, s47, 13
    v_add_u32 v8, s57, v16
    v_xor_b32 v9, 16, v8
    v_xor_b32 v10, 32, v8
    v_xor_b32 v11, 48, v8
    v_lshrrev_b32 v16, 2, v0
    v_and_b32 v17, 7, v16
    v_lshlrev_b32 v17, 1, v17
    v_lshrrev_b32 v18, 3, v16
    v_or_b32 v17, v17, v18
    v_bfe_u32 v18, v0, 1, 1
    v_xor_b32 v17, v17, v18
    v_lshlrev_b32 v17, 4, v17
    v_lshl_add_u32 v17, v16, 8, v17
    v_and_b32 v18, 1, v0
    v_lshl_add_u32 v17, v18, 3, v17
    s_lshl_b32 s57, s47, 6
    v_xor_b32 v4, s57, v17
    v_xor_b32 v5, 32, v4
    v_and_b32 v16, 3, v3
    v_lshlrev_b32 v17, 6, v2
    v_lshl_add_u32 v23, v16, 8, v17
    v_add_u32 v23, 148480, v23
    v_lshl_add_u32 v6, v16, 4, v17
    v_add_u32 v6, 155648, v6
    v_lshrrev_b32 v18, 2, v3
    v_lshl_add_u32 v1, v18, 10, v6
    s_lshl_b32 s57, s47, 8
    v_add_u32 v1, s57, v1
    v_lshlrev_b32 v19, 3, v16
    v_add_u32 v19, 147584, v19
    s_lshl_b32 s57, s47, 5
    v_add_u32 v22, s57, v19
    s_lshl_b32 s57, s47, 2
    v_add_u32 v7, s57, v21
    v_lshl_add_u32 v24, v18, 2, v2
    v_lshlrev_b32 v24, 7, v24
    v_lshl_add_u32 v44, v16, 12, v24
    v_lshlrev_b32 v45, 2, v3
    v_and_b32 v17, 1, v2
    v_lshl_add_u32 v45, v17, 6, v45
    v_lshrrev_b32 v17, 1, v2
    v_lshl_add_u32 v45, v17, 12, v45
    v_lshlrev_b32 v46, 4, v0
    v_mov_b64 v[72:73], 0
    v_mov_b64 v[74:75], 0
    v_mov_b64 v[76:77], 0
    v_mov_b64 v[78:79], 0
    s_lshl_b32 s66, s53, 14
    s_lshl_b32 s57, s47, 10
    s_add_u32 s66, s66, s57
    s_lshl_b32 s57, s52, 4
    s_add_u32 s66, s66, s57
    s_add_u32 s66, s66, 1048576
    s_lshl_b32 s67, s47, 3
    s_add_u32 s67, s67, s54
    s_lshl_b32 s67, s67, 2
    s_add_u32 s67, s67, s55
    s_lshl_b32 s67, s67, 12
    s_add_u32 s67, s67, 1048576
    s_lshl_b32 s68, s47, 16
    s_lshl_b32 s57, s52, 13
    s_add_u32 s68, s68, s57
    s_lshl_b32 s57, s53, 7
    s_add_u32 s68, s68, s57
    s_add_u32 s68, s68, 1572864
    s_lshl_b32 s57, s55, 3
    s_add_u32 s57, s57, 147520
    v_mov_b32 v24, s57
    s_add_u32 s59, s47, 2
    s_mov_b32 s60, 0
    s_mov_b32 s74, 0x000f000f
    s_mov_b32 s75, 0x000f000f
    s_mov_b32 s31, 131071
    s_waitcnt lgkmcnt(0)
    s_mov_b32 s40, s28
    s_mov_b32 s41, s29
    s_mov_b32 s42, 4194304
    s_mov_b32 s43, 0x20000
    s_barrier
    s_mov_b64 exec, 0
    s_branch Lpad_C_0
Lret_C:
    s_mov_b64 exec, -1
L_lw10:
    ds_read_b32 v20, v21 offset:4
    s_waitcnt lgkmcnt(0)
    v_readfirstlane_b32 s56, v20
    s_nop 0
    s_cmp_ge_i32 s56, 1
    s_cbranch_scc1 L_lw10_ok
    s_sleep 2
    s_sub_u32 s71, s71, 1
    s_cbranch_scc0 L_lw10
    s_endpgm
L_lw10_ok:
    ds_read_b32 v24, v24
    ds_read_b128 v[120:123], v23 offset:0
    ds_read_b128 v[124:127], v23 offset:16
    ds_read_b128 v[128:131], v23 offset:32
    ds_read_b128 v[132:135], v23 offset:48
    ds_read_b64 v[26:27], v21 offset:48
    s_mov_b32 s56, 0
    s_waitcnt lgkmcnt(0)
    v_readfirstlane_b32 s61, v24
    v_readfirstlane_b32 s30, v26
    v_readfirstlane_b32 s72, v27
L_kloop:
Lpad_C_0:
    s_cbranch_execz Lpad_C_1
    s_cmp_ge_i32 s56, s59
    s_cbranch_scc1 L_lw11_ok
L_lw11:
    ds_read_b32 v20, v21 offset:0
    s_waitcnt lgkmcnt(0)
    v_readfirstlane_b32 s56, v20
    s_nop 0
    s_cmp_ge_i32 s56, s59
    s_cbranch_scc1 L_lw11_ok
    s_sleep 1
    s_sub_u32 s71, s71, 1
    s_cbranch_scc0 L_lw11
    s_endpgm
L_lw11_ok:
    ds_read_b128 v[88:91], v8 offset:0
    ds_read_b128 v[92:95], v8 offset:4096
    ds_read_b128 v[96:99], v9 offset:0
    ds_read_b128 v[100:103], v9 offset:4096
    ds_read_b128 v[104:107], v10 offset:0
    ds_read_b128 v[108:111], v10 offset:4096
    ds_read_b128 v[112:115], v11 offset:0
    ds_read_b128 v[116:119], v11 offset:4096
    s_add_u32 s59, s59, 4
    s_sub_u32 s57, s59, 2
    s_min_u32 s57, s57, 32
    v_mov_b32 v20, s57
    s_waitcnt lgkmcnt(6)
    v_mfma_f32_16x16x32_bf16 v[32:35], v[88:91], v[120:123], 0
    v_mfma_f32_16x16x32_bf16 v[36:39], v[92:95], v[120:123], 0
    s_waitcnt lgkmcnt(4)
    v_mfma_f32_16x16x32_bf16 v[32:35], v[96:99], v[124:127], v[32:35]
    v_mfma_f32_16x16x32_bf16 v[36:39], v[100:103], v[124:127], v[36:39]
    s_waitcnt lgkmcnt(2)
    v_mfma_f32_16x16x32_bf16 v[32:35], v[104:107], v[128:131], v[32:35]
    v_mfma_f32_16x16x32_bf16 v[36:39], v[108:111], v[128:131], v[36:39]
    s_waitcnt lgkmcnt(0)
    ds_write_b32 v7, v20 offset:16
    v_mfma_f32_16x16x32_bf16 v[32:35], v[112:115], v[132:135], v[32:35]
    v_mfma_f32_16x16x32_bf16 v[36:39], v[116:119], v[132:135], v[36:39]
Lpad_C_1:
    s_cbranch_execz Lpad_C_2
    v_add_u32 v8, 0x8000, v8
    v_add_u32 v9, 0x8000, v9
    v_add_u32 v10, 0x8000, v10
    v_add_u32 v11, 0x8000, v11
    v_and_b32 v8, 0x1ffff, v8
    v_and_b32 v9, 0x1ffff, v9
    v_and_b32 v10, 0x1ffff, v10
    v_and_b32 v11, 0x1ffff, v11
    s_mov_b64 exec, s[74:75]
    v_mov_b64 v[56:57], v[32:33]
    v_mov_b64 v[58:59], v[34:35]
    v_mov_b64 v[60:61], v[36:37]
    v_mov_b64 v[62:63], v[38:39]
    s_mov_b64 exec, -1
    s_lshl_b64 s[74:75], s[74:75], 4
    s_add_u32 s60, s60, 1
    s_and_b32 s57, s60, 3
    s_cbranch_scc1 L_kloop
    s_mov_b32 s74, 0x000f000f
    s_mov_b32 s75, 0x000f000f
    s_cmp_eq_u32 s60, 8
    s_cbranch_scc1 L_soft
    v_mov_b64 v[64:65], v[56:57]
    v_mov_b64 v[66:67], v[58:59]
    v_mov_b64 v[68:69], v[60:61]
    v_mov_b64 v[70:71], v[62:63]
    s_branch L_kloop
L_soft:
    v_max3_f32 v16, v56, v57, v58
    v_max3_f32 v16, v16, v59, v60
    v_max3_f32 v16, v16, v61, v62
    v_max3_f32 v16, v16, v63, v64
    v_max3_f32 v16, v16, v65, v66
    v_max3_f32 v16, v16, v67, v68
    v_max3_f32 v16, v16, v69, v70
    v_max_f32 v16, v16, v71
    s_nop 1
    v_max_f32_dpp v16, v16, v16 row_ror:4 row_mask:0xf bank_mask:0xf
    s_nop 1
    v_max_f32_dpp v16, v16, v16 row_ror:8 row_mask:0xf bank_mask:0xf
    v_mov_b32 v24, v16
    s_nop 1
    v_permlane32_swap_b32 v16, v24
    v_max_f32 v16, v16, v24
    v_mov_b32 v24, v16
    s_nop 1
    v_permlane16_swap_b32 v16, v24
    v_max_f32 v16, v16, v24
    v_mul_f32 v16, s61, v16
    v_fma_f32 v56, v56, s61, -v16
    v_fma_f32 v57, v57, s61, -v16
    v_fma_f32 v58, v58, s61, -v16
    v_fma_f32 v59, v59, s61, -v16
    v_fma_f32 v60, v60, s61, -v16
    v_fma_f32 v61, v61, s61, -v16
    v_fma_f32 v62, v62, s61, -v16
    v_fma_f32 v63, v63, s61, -v16
    v_fma_f32 v64, v64, s61, -v16
    v_fma_f32 v65, v65, s61, -v16
    v_fma_f32 v66, v66, s61, -v16
    v_fma_f32 v67, v67, s61, -v16
    v_fma_f32 v68, v68, s61, -v16
    v_fma_f32 v69, v69, s61, -v16
    v_fma_f32 v70, v70, s61, -v16
    v_fma_f32 v71, v71, s61, -v16
Lpad_C_2:
    s_cbranch_execz Lpad_C_3
    v_exp_f32 v56, v56
    v_exp_f32 v57, v57
    v_exp_f32 v58, v58
    v_exp_f32 v59, v59
    v_exp_f32 v60, v60
    v_exp_f32 v61, v61
    v_exp_f32 v62, v62
    v_exp_f32 v63, v63
    v_exp_f32 v64, v64
    v_exp_f32 v65, v65
    v_exp_f32 v66, v66
    v_exp_f32 v67, v67
    v_exp_f32 v68, v68
    v_exp_f32 v69, v69
    v_exp_f32 v70, v70
    v_exp_f32 v71, v71
    v_add_f32 v17, v56, v57
    v_add_f32 v18, v58, v59
    v_add_f32 v17, v17, v60
    v_add_f32 v18, v18, v61
    v_add_f32 v17, v17, v62
    v_add_f32 v18, v18, v63
    v_add_f32 v17, v17, v64
    v_add_f32 v18, v18, v65
    v_add_f32 v17, v17, v66
    v_add_f32 v18, v18, v67
    v_add_f32 v17, v17, v68
    v_add_f32 v18, v18, v69
    v_add_f32 v17, v17, v70
    v_add_f32 v18, v18, v71
    v_add_f32 v17, v17, v18
    s_nop 1
    v_add_f32_dpp v17, v17, v17 row_ror:4 row_mask:0xf bank_mask:0xf
    s_nop 1
    v_add_f32_dpp v17, v17, v17 row_ror:8 row_mask:0xf bank_mask:0xf
    v_mov_b32 v24, v17
    s_nop 1
    v_permlane32_swap_b32 v17, v24
    v_add_f32 v17, v17, v24
    v_mov_b32 v24, v17
    s_nop 1
    v_permlane16_swap_b32 v17, v24
    v_add_f32 v17, v17, v24
    ds_write_b64 v22, v[16:17]
    v_mov_b32 v20, 1
    s_mov_b64 exec, 1
    ds_add_u32 v21, v20 offset:32
    s_mov_b64 exec, -1
Lpad_C_3:
    s_cbranch_execz Lpad_C_4
L_lw12:
    ds_read_b32 v20, v21 offset:32
    s_waitcnt lgkmcnt(0)
    v_readfirstlane_b32 s57, v20
    s_nop 0
    s_cmp_ge_i32 s57, 4
    s_cbranch_scc1 L_lw12_ok
    s_sleep 1
    s_sub_u32 s71, s71, 1
    s_cbranch_scc0 L_lw12
    s_endpgm
L_lw12_ok:
    ds_read_b64 v[32:33], v19 offset:0
    ds_read_b64 v[34:35], v19 offset:32
    ds_read_b64 v[36:37], v19 offset:64
    ds_read_b64 v[38:39], v19 offset:96
    s_waitcnt lgkmcnt(0)
    v_max3_f32 v42, v32, v34, v36
    v_max_f32 v42, v42, v38
    v_sub_f32 v32, v32, v42
    v_sub_f32 v34, v34, v42
    v_sub_f32 v36, v36, v42
    v_sub_f32 v38, v38, v42
    v_sub_f32 v16, v16, v42
    v_exp_f32 v32, v32
    v_exp_f32 v34, v34
    v_exp_f32 v36, v36
    v_exp_f32 v38, v38
    v_exp_f32 v16, v16
    v_mul_f32 v17, v32, v33
    v_fmac_f32 v17, v34, v35
    v_fmac_f32 v17, v36, v37
    v_fmac_f32 v17, v38, v39
    v_rcp_f32 v18, v17
    v_log_f32 v17, v17
    v_mov_b32 v43, s30
    v_mul_f32 v16, v16, v18
    v_add_f32 v42, v42, v17
    v_mul_f32 v56, v16, v56
    v_mul_f32 v57, v16, v57
    v_mul_f32 v58, v16, v58
    v_mul_f32 v59, v16, v59
    v_mul_f32 v60, v16, v60
    v_mul_f32 v61, v16, v61
    v_mul_f32 v62, v16, v62
    v_mul_f32 v63, v16, v63
    v_mul_f32 v64, v16, v64
    v_mul_f32 v65, v16, v65
    v_mul_f32 v66, v16, v66
    v_mul_f32 v67, v16, v67
    v_mul_f32 v68, v16, v68
    v_mul_f32 v69, v16, v69
    v_mul_f32 v70, v16, v70
    v_mul_f32 v71, v16, v71
    v_cvt_pk_bf16_f32 v56, v56, v57
    v_cvt_pk_bf16_f32 v57, v58, v59
    v_cvt_pk_bf16_f32 v58, v60, v61
    v_cvt_pk_bf16_f32 v59, v62, v63
    v_cvt_pk_bf16_f32 v60, v64, v65
    v_cvt_pk_bf16_f32 v61, v66, v67
    v_cvt_pk_bf16_f32 v62, v68, v69
    v_cvt_pk_bf16_f32 v63, v70, v71
    ds_write_b128 v1, v[60:63]
    ds_write_b128 v1, v[56:59] offset:4096
    v_mov_b32 v20, 1
    s_mov_b64 exec, 1
    ds_add_u32 v21, v20 offset:36
    s_mov_b64 exec, -1
    v_mov_b32 v53, s30
    s_mov_b32 s59, 34
L_lw13:
    ds_read_b32 v20, v21 offset:36
    s_waitcnt lgkmcnt(0)
    v_readfirstlane_b32 s57, v20
    s_nop 0
    s_cmp_ge_i32 s57, 4
    s_cbranch_scc1 L_lw13_ok
    s_sleep 1
    s_sub_u32 s71, s71, 1
    s_cbranch_scc0 L_lw13
    s_endpgm
L_lw13_ok:
L_vloop:
Lpad_C_4:
    s_cbranch_execz Lpad_C_5
    s_cmp_ge_i32 s56, s59
    s_cbranch_scc1 L_lw14_ok
L_lw14:
    ds_read_b32 v20, v21 offset:0
    s_waitcnt lgkmcnt(0)
    v_readfirstlane_b32 s56, v20
    s_nop 0
    s_cmp_ge_i32 s56, s59
    s_cbranch_scc1 L_lw14_ok
    s_sleep 1
    s_sub_u32 s71, s71, 1
    s_cbranch_scc0 L_lw14
    s_endpgm
L_lw14_ok:
    ds_read_b128 v[28:31], v6 offset:0
    ds_read_b64_tr_b16 v[80:81], v4 offset:0
    ds_read_b64_tr_b16 v[82:83], v4 offset:4096
    ds_read_b64_tr_b16 v[84:85], v5 offset:0
    ds_read_b64_tr_b16 v[86:87], v5 offset:4096
    s_sub_u32 s57, s59, 1
    v_mov_b32 v20, s57
    s_add_u32 s59, s59, 1
    v_add_u32 v6, 256, v6
    s_waitcnt lgkmcnt(2)
    v_mfma_f32_16x16x32_bf16 v[72:75], v[80:83], v[28:31], v[72:75]
    s_waitcnt lgkmcnt(0)
    v_mfma_f32_16x16x32_bf16 v[76:79], v[84:87], v[28:31], v[76:79]
    ds_write_b32 v7, v20 offset:16
    v_add_u32 v4, 8192, v4
    v_add_u32 v5, 8192, v5
    v_and_b32 v4, 0x1ffff, v4
    v_and_b32 v5, 0x1ffff, v5
    s_cmp_lt_u32 s59, 65
    s_cbranch_scc1 L_vloop
Lpad_C_5:
    s_cbranch_execz Lpad_C_6
    ds_read_b128 v[28:31], v6 offset:0
    s_barrier
    ds_read_b64_tr_b16 v[80:81], v4 offset:0
    ds_read_b64_tr_b16 v[82:83], v4 offset:4096
    ds_read_b64_tr_b16 v[84:85], v5 offset:0
    ds_read_b64_tr_b16 v[86:87], v5 offset:4096
    s_waitcnt lgkmcnt(2)
    v_mfma_f32_16x16x32_bf16 v[72:75], v[80:83], v[28:31], v[72:75]
    s_waitcnt lgkmcnt(0)
    v_mfma_f32_16x16x32_bf16 v[76:79], v[84:87], v[28:31], v[76:79]
    s_mov_b32 exec_lo, 0x00ff00ff
    s_mov_b32 exec_hi, 0x00ff00ff
    s_nop 3
    v_cvt_pk_bf16_f32 v40, v72, v73
    v_cvt_pk_bf16_f32 v41, v74, v75
    v_cvt_pk_bf16_f32 v32, v76, v77
    v_cvt_pk_bf16_f32 v33, v78, v79
    s_cmp_eq_u32 s72, 1
    v_mov_b32_dpp v40, v32 quad_perm:[0,1,2,3] row_mask:0xf bank_mask:0x2
    v_mov_b32_dpp v41, v33 quad_perm:[0,1,2,3] row_mask:0xf bank_mask:0x2
    s_cbranch_scc0 L_ofar
    buffer_store_dwordx4 v[40:43], v44, s[40:43], s66 offen
L_onear:
    s_mov_b64 exec, -1
    buffer_load_dwordx4 v[56:59], v46, s[40:43], s67 offen offset:0 sc1
    buffer_load_dwordx4 v[60:63], v46, s[40:43], s67 offen offset:1024 sc1
    buffer_load_dwordx4 v[64:67], v46, s[40:43], s67 offen offset:2048 sc1
    buffer_load_dwordx4 v[68:71], v46, s[40:43], s67 offen offset:3072 sc1
    s_barrier
    ds_read_b64_tr_b16 v[88:89], v12 offset:0
    ds_read_b64_tr_b16 v[90:91], v12 offset:512
Lpad_C_6:
    s_cbranch_execz Lpad_C_7
    ds_read_b64_tr_b16 v[92:93], v13 offset:0
    ds_read_b64_tr_b16 v[94:95], v13 offset:512
    ds_read_b64_tr_b16 v[96:97], v14 offset:0
    ds_read_b64_tr_b16 v[98:99], v14 offset:512
    ds_read_b64_tr_b16 v[100:101], v15 offset:0
    ds_read_b64_tr_b16 v[102:103], v15 offset:512
    ds_read_b64_tr_b16 v[104:105], v12 offset:4096
    ds_read_b64_tr_b16 v[106:107], v12 offset:4608
    ds_read_b64_tr_b16 v[108:109], v13 offset:4096
    ds_read_b64_tr_b16 v[110:111], v13 offset:4608
    s_waitcnt lgkmcnt(12)
    ds_read_b64_tr_b16 v[112:113], v14 offset:4096
    ds_read_b64_tr_b16 v[114:115], v14 offset:4608
    s_waitcnt lgkmcnt(12)
    ds_read_b64_tr_b16 v[116:117], v15 offset:4096
    ds_read_b64_tr_b16 v[118:119], v15 offset:4608
    s_waitcnt lgkmcnt(12)
    ds_read_b64_tr_b16 v[120:121], v12 offset:8192
    ds_read_b64_tr_b16 v[122:123], v12 offset:8704
    s_waitcnt lgkmcnt(12)
    ds_read_b64_tr_b16 v[124:125], v13 offset:8192
    ds_read_b64_tr_b16 v[126:127], v13 offset:8704
    s_waitcnt lgkmcnt(12)
    ds_read_b64_tr_b16 v[128:129], v14 offset:8192
    ds_read_b64_tr_b16 v[130:131], v14 offset:8704
    s_waitcnt lgkmcnt(12)
    ds_read_b64_tr_b16 v[132:133], v15 offset:8192
    ds_read_b64_tr_b16 v[134:135], v15 offset:8704
Lpad_C_7:
    s_cbranch_execz Lpad_C_8
    s_waitcnt lgkmcnt(12)
    ds_read_b64_tr_b16 v[136:137], v12 offset:12288
    ds_read_b64_tr_b16 v[138:139], v12 offset:12800
    s_waitcnt lgkmcnt(12)
    ds_read_b64_tr_b16 v[140:141], v13 offset:12288
    ds_read_b64_tr_b16 v[142:143], v13 offset:12800
    s_waitcnt lgkmcnt(12)
    ds_read_b64_tr_b16 v[144:145], v14 offset:12288
    ds_read_b64_tr_b16 v[146:147], v14 offset:12800
    s_waitcnt lgkmcnt(12)
    ds_read_b64_tr_b16 v[148:149], v15 offset:12288
    ds_read_b64_tr_b16 v[150:151], v15 offset:12800
    s_branch L_po1
L_po:
    buffer_load_dwordx4 v[56:59], v46, s[40:43], s67 offen offset:0 sc1
    buffer_load_dwordx4 v[60:63], v46, s[40:43], s67 offen offset:1024 sc1
    buffer_load_dwordx4 v[64:67], v46, s[40:43], s67 offen offset:2048 sc1
    buffer_load_dwordx4 v[68:71], v46, s[40:43], s67 offen offset:3072 sc1
L_po1:
    s_waitcnt vmcnt(0)
    v_cmpx_eq_u32 vcc, s30, v59
    v_cmpx_eq_u32 vcc, s30, v63
    v_cmpx_eq_u32 vcc, s30, v67
    v_cmpx_eq_u32 vcc, s30, v71
    s_nop 1
    s_cmp_eq_u64 exec, -1
    s_mov_b64 exec, -1
    s_cbranch_scc1 L_po_ok
    s_sub_u32 s31, s31, 1
    s_cbranch_scc0 L_po
L_po_ok:
    v_mov_b32 v18, v58
    v_mov_b32_dpp v58, v56 row_shl:8 row_mask:0xf bank_mask:0xf bound_ctrl:1
    v_mov_b32_dpp v59, v57 row_shl:8 row_mask:0xf bank_mask:0xf bound_ctrl:1
    v_mov_b32_dpp v62, v60 row_shl:8 row_mask:0xf bank_mask:0xf bound_ctrl:1
    v_mov_b32_dpp v63, v61 row_shl:8 row_mask:0xf bank_mask:0xf bound_ctrl:1
    v_mov_b32_dpp v66, v64 row_shl:8 row_mask:0xf bank_mask:0xf bound_ctrl:1
    v_mov_b32_dpp v67, v65 row_shl:8 row_mask:0xf bank_mask:0xf bound_ctrl:1
    v_mov_b32_dpp v70, v68 row_shl:8 row_mask:0xf bank_mask:0xf bound_ctrl:1
    v_mov_b32_dpp v71, v69 row_shl:8 row_mask:0xf bank_mask:0xf bound_ctrl:1
    s_waitcnt lgkmcnt(0)
    v_mfma_f32_16x16x32_bf16 v[72:75], v[56:59], v[88:91], 0
    v_max_f32_dpp v19, v18, v18 quad_perm:[1,0,3,2] row_mask:0xf bank_mask:0xf
Lpad_C_8:
    s_cbranch_execz Lpad_C_9
    v_mfma_f32_16x16x32_bf16 v[76:79], v[56:59], v[92:95], 0
    v_max_f32_dpp v19, v19, v19 quad_perm:[2,3,0,1] row_mask:0xf bank_mask:0xf
    v_mfma_f32_16x16x32_bf16 v[72:75], v[60:63], v[104:107], v[72:75]
    s_nop 0
    v_max_f32_dpp v19, v19, v19 row_half_mirror row_mask:0xf bank_mask:0xf
    v_mfma_f32_16x16x32_bf16 v[76:79], v[60:63], v[108:111], v[76:79]
    v_sub_f32 v18, v18, v19
    v_mfma_f32_16x16x32_bf16 v[72:75], v[64:67], v[120:123], v[72:75]
    v_exp_f32 v18, v18
    v_mfma_f32_16x16x32_bf16 v[76:79], v[64:67], v[124:127], v[76:79]
    s_nop 0
    v_add_f32_dpp v19, v18, v18 quad_perm:[1,0,3,2] row_mask:0xf bank_mask:0xf
    v_mfma_f32_16x16x32_bf16 v[72:75], v[68:71], v[136:139], v[72:75]
    s_nop 0
    v_add_f32_dpp v19, v19, v19 quad_perm:[2,3,0,1] row_mask:0xf bank_mask:0xf
    v_mfma_f32_16x16x32_bf16 v[76:79], v[68:71], v[140:143], v[76:79]
    s_nop 0
    v_add_f32_dpp v19, v19, v19 row_half_mirror row_mask:0xf bank_mask:0xf
    v_mfma_f32_16x16x32_bf16 v[80:83], v[56:59], v[96:99], 0
    v_rcp_f32 v19, v19
    v_mfma_f32_16x16x32_bf16 v[84:87], v[56:59], v[100:103], 0
    v_mul_f32 v18, v18, v19
    v_mfma_f32_16x16x32_bf16 v[80:83], v[60:63], v[112:115], v[80:83]
    s_nop 0
    v_mov_b32_dpp v32, v18 row_newbcast:0 row_mask:0x5 bank_mask:0xf
    v_mov_b32_dpp v33, v18 row_newbcast:1 row_mask:0x5 bank_mask:0xf
    v_mov_b32_dpp v34, v18 row_newbcast:2 row_mask:0x5 bank_mask:0xf
    v_mov_b32_dpp v35, v18 row_newbcast:3 row_mask:0x5 bank_mask:0xf
Lpad_C_9:
    s_cbranch_execz Lpad_C_10
    v_mfma_f32_16x16x32_bf16 v[84:87], v[60:63], v[116:119], v[84:87]
    v_mov_b32_dpp v32, v18 row_newbcast:4 row_mask:0xa bank_mask:0xf
    v_mov_b32_dpp v33, v18 row_newbcast:5 row_mask:0xa bank_mask:0xf
    v_mov_b32_dpp v34, v18 row_newbcast:6 row_mask:0xa bank_mask:0xf
    v_mov_b32_dpp v35, v18 row_newbcast:7 row_mask:0xa bank_mask:0xf
    v_mfma_f32_16x16x32_bf16 v[80:83], v[64:67], v[128:131], v[80:83]
    v_mfma_f32_16x16x32_bf16 v[84:87], v[64:67], v[132:135], v[84:87]
    v_mul_f32 v52, v32, v72
    v_fmac_f32 v52, v33, v73
    v_fmac_f32 v52, v34, v74
    v_fmac_f32 v52, v35, v75
    v_mfma_f32_16x16x32_bf16 v[80:83], v[68:71], v[144:147], v[80:83]
    v_mul_f32 v36, v32, v76
    v_fmac_f32 v36, v33, v77
    v_fmac_f32 v36, v34, v78
    v_fmac_f32 v36, v35, v79
    v_mfma_f32_16x16x32_bf16 v[84:87], v[68:71], v[148:151], v[84:87]
    s_nop 0
    v_permlane16_swap_b32 v52, v36
    s_nop 0
    v_mul_f32 v37, v32, v80
    v_fmac_f32 v37, v33, v81
    v_fmac_f32 v37, v34, v82
    v_fmac_f32 v37, v35, v83
    v_add_f32 v52, v52, v36
    v_mul_f32 v38, v32, v84
    v_fmac_f32 v38, v33, v85
    v_fmac_f32 v38, v34, v86
    v_fmac_f32 v38, v35, v87
Lpad_C_10:
    s_cbranch_execz Lret_C
    s_nop 0
    v_permlane16_swap_b32 v37, v38
    v_add_f32 v37, v37, v38
    s_nop 1
    v_permlane32_swap_b32 v52, v37
    s_nop 1
    v_mov_b32_dpp v36, v52 quad_perm:[1,0,3,2] row_mask:0xf bank_mask:0xf
    s_mov_b32 exec_lo, 0x55555555
    s_mov_b32 exec_hi, 0x55555555
    v_cvt_pk_bf16_f32 v52, v52, v36
    buffer_store_dwordx2 v[52:53], v45, s[40:43], s68 offen sc1
    s_endpgm
L_ofar:
    buffer_store_dwordx4 v[40:43], v44, s[40:43], s66 offen sc1
    s_branch L_onear
.section .rodata,"a"
.p2align 6
.amdhsa_kernel recurrent_scan__gqa_block_cached__mixer_channel_mlp__decode_kernel
  .amdhsa_next_free_vgpr 184
  .amdhsa_next_free_sgpr 102
  .amdhsa_accum_offset 184
  .amdhsa_group_segment_fixed_size 0
  .amdhsa_kernarg_size 104
  .amdhsa_user_sgpr_count 2
  .amdhsa_user_sgpr_kernarg_segment_ptr 1
  .amdhsa_system_sgpr_workgroup_id_x 1
.end_amdhsa_kernel
```
